```python
import torch

def _softmax(x, axis=-1):
    return torch.softmax(x, dim=axis)

def _gelu(x):
    return torch.nn.functional.gelu(x, approximate='tanh')

def _silu(x):
    return torch.nn.functional.silu(x)

def _sigmoid(x):
    return torch.sigmoid(x)

def _layernorm(x, axis=-1, eps=1e-05):
    m = x.mean(dim=axis, keepdim=True)
    v = x.var(dim=axis, keepdim=True, unbiased=False)
    return (x - m) / torch.sqrt(v + eps)

def _scatter_add(tgt, idx, src, axis=0):
    return tgt.clone().index_add_(axis, idx, src)

def _segment_sum(src, seg, n):
    out = torch.zeros((n,) + src.shape[1:], dtype=src.dtype)
    return out.index_add_(0, seg, src)

def _pad(x, pw):
    flat = tuple((v for pair in reversed(pw) for v in pair))
    return torch.nn.functional.pad(x, flat)
kernel_name = 'adaLN_cond__gqa_block_cached__dense_activation_silu__decode'

def setup_inputs():

    _w = lambda a: (lambda t: t.to(torch.bfloat16) if t.is_floating_point() else t)(torch.as_tensor(a))

    def _A_setup():
        B, Sq, D = (1, 1, 640)
        Hq, Hkv, Sk, Dh = (32, 32, 16384, 192)
        assert Hq % Hkv == 0, (Hq, Hkv)
        return {'x': _w((lambda *s: torch.randn(*s, dtype=torch.bfloat16) * 0.1)(B, Sq, D)), 'k_cache': _w((lambda *s: torch.randn(*s, dtype=torch.bfloat16) * 0.8)(B, Hkv, Sk, Dh)), 'v_cache': _w((lambda *s: torch.randn(*s, dtype=torch.bfloat16) * 3.2)(B, Hkv, Sk, Dh)), 'wq': _w((lambda *s: torch.randn(*s, dtype=torch.bfloat16) * 0.8)(D, Hq * Dh) * D ** (-0.5)), 'wo': _w((lambda *s: torch.randn(*s, dtype=torch.bfloat16) * 3.2)(Hq * Dh, D) * (Hq * Dh) ** (-0.5))}
    _A_in = _A_setup()

    def _B_setup():
        B, S, D, F = (1, 1, 640, 1536)
        return {'x': _w((lambda *s: torch.randn(*s, dtype=torch.bfloat16) * 0.1)(B, S, D)), 'w1': _w((lambda *s: torch.randn(*s, dtype=torch.bfloat16) * 3.2)(D, F) * D ** (-0.5)), 'w2': _w((lambda *s: torch.randn(*s, dtype=torch.bfloat16) * 3.2)(F, D) * F ** (-0.5))}
    _B_in = _B_setup()
    return {'A_x': _A_in['x'], 'A_k_cache': _A_in['k_cache'], 'A_v_cache': _A_in['v_cache'], 'A_wq': _A_in['wq'], 'A_wo': _A_in['wo'], 'B_x': _B_in['x'], 'B_w1': _B_in['w1'], 'B_w2': _B_in['w2'], 'c': _w((lambda *s: torch.randn(*s, dtype=torch.bfloat16) * 0.2)(1, 640) * 8.0), 'w_mod': _w((lambda *s: torch.randn(*s, dtype=torch.bfloat16) * 0.2)(640, 6 * 640) * 640 ** (-0.5) * 8.0)}

def reference(A_x, A_k_cache, A_v_cache, A_wq, A_wo, B_x, B_w1, B_w2, c, w_mod):

    def _A_ref(x, k_cache, v_cache, wq, wo):
        B, Sq, D = x.shape
        Hq, Dh = (32, 192)
        Hkv = k_cache.shape[1]
        rep = Hq // Hkv
        q = (lambda x, *d: x.permute(*d))((x @ wq).reshape(B, Sq, Hq, Dh), 0, 2, 1, 3)
        k = (lambda x, n, axis: torch.repeat_interleave(x, n, dim=axis))(k_cache, rep, axis=1)
        v = (lambda x, n, axis: torch.repeat_interleave(x, n, dim=axis))(v_cache, rep, axis=1)
        scores = torch.einsum('bhqd,bhkd->bhqk', q, k) * Dh ** (-0.5)
        p = _softmax(scores, axis=-1)
        o = torch.einsum('bhqk,bhkd->bhqd', p, v)
        return (lambda x, *d: x.permute(*d))(o, 0, 2, 1, 3).reshape(B, Sq, Hq * Dh) @ wo

    def _B_ref(x, w1, w2):
        h = torch.einsum('bsd,df->bsf', x, w1)
        h = _silu(h)
        out = torch.einsum('bsf,fd->bsd', h, w2)
        return out
    x = A_x
    mod = (_silu(c) @ w_mod).reshape(c.shape[0], 6, 1, -1)
    sa, ca, ga, sb, cb, gb = (mod[:, 0].clone(), mod[:, 1].clone(), mod[:, 2].clone(), mod[:, 3].clone(), mod[:, 4].clone(), mod[:, 5].clone())
    h = _layernorm(x, axis=-1) * (1 + ca) + sa
    x = x + ga * _A_ref(h, A_k_cache, A_v_cache, A_wq, A_wo)
    h = _layernorm(x, axis=-1) * (1 + cb) + sb
    x = x + gb * _B_ref(h, B_w1, B_w2)
    return x
```

```asm
; @launch grid=(256,1,1) block=(512,1,1) lds=147584
.amdgcn_target "amdgcn-amd-amdhsa--gfx950"
.text
.globl adaLN_cond__gqa_block_cached__dense_activation_silu__decode_kernel
.p2align 8
.type adaLN_cond__gqa_block_cached__dense_activation_silu__decode_kernel,@function
adaLN_cond__gqa_block_cached__dense_activation_silu__decode_kernel:
    s_cmp_ge_u32 s2, 256
    s_cbranch_scc1 L_end
    s_load_dwordx16 s[16:31], s[0:1], 0
    s_load_dwordx8 s[32:39], s[0:1], 64
    s_load_dwordx2 s[40:41], s[0:1], 96
    v_lshrrev_b32 v1, 6, v0
    v_and_b32 v0, 63, v0
    v_readfirstlane_b32 s3, v1
    s_lshr_b32 s4, s2, 3
    s_and_b32 s5, s2, 7
    v_lshrrev_b32 v1, 3, v0
    v_and_b32 v2, 7, v0
    v_lshlrev_b32 v3, 4, v2
    s_mov_b32 s69, s3
    s_cmp_ge_u32 s3, 4
    s_cbranch_scc1 L_service
    v_mul_u32_u24 v1, 384, v1
    v_add_u32 v1, v1, v3
    s_mul_i32 s42, s4, 6291456
    s_lshl_b32 s43, s5, 2
    s_add_u32 s43, s43, s3
    s_mul_i32 s60, s43, 6144
    s_mov_b32 s48, s60
    s_mov_b32 s61, 196608
    s_mov_b32 s63, 1073741824
    s_lshl_b32 s56, s4, 8
    s_add_u32 s56, s56, 4096
    s_mov_b32 s62, 30
    s_waitcnt lgkmcnt(0)
    s_add_u32 s18, s18, s42
    s_addc_u32 s19, s19, 0
    s_add_u32 s20, s20, s42
    s_addc_u32 s21, s21, 0
    s_mov_b32 s8, s18
    s_mov_b32 s9, s19
    s_mov_b32 s10, 6291456
    s_mov_b32 s11, 0x20000
    s_add_u32 s12, s18, 3072
    s_addc_u32 s13, s19, 0
    s_mov_b32 s14, 6291456
    s_mov_b32 s15, 0x20000
    s_barrier
    s_waitcnt vmcnt(9)
    buffer_load_dwordx4 v[48:51], v1, s[8:11], s60 offen offset:0 nt
    buffer_load_dwordx4 v[52:55], v1, s[8:11], s60 offen offset:128 nt
    buffer_load_dwordx4 v[56:59], v1, s[8:11], s60 offen offset:256 nt
    s_waitcnt vmcnt(9)
    buffer_load_dwordx4 v[60:63], v1, s[12:15], s60 offen offset:0 nt
    buffer_load_dwordx4 v[64:67], v1, s[12:15], s60 offen offset:128 nt
    buffer_load_dwordx4 v[68:71], v1, s[12:15], s60 offen offset:256 nt
    s_add_u32 s60, s60, s61
    s_sub_u32 s62, s62, 1
    s_load_dword s6, s[40:41], 0
    s_add_u32 s64, s40, s56
    s_addc_u32 s65, s41, 0
    s_getpc_b64 s[54:55]
        L_pc_0:
    s_add_u32 s54, s54, L_table - L_pc_0
    s_addc_u32 s55, s55, 0
    s_and_b32 s56, s2, 0xfc
    s_load_dword s53, s[54:55], s56
    s_mov_b32 s44, s40
    s_mov_b32 s45, s41
    s_mov_b32 s46, 805306368
    s_mov_b32 s47, 0x20000
    v_and_b32 v36, 1, v0
    v_lshlrev_b32 v36, 4, v36
    v_mov_b32 v37, 0xffff
    v_lshlrev_b32 v39, v36, v37
    v_bfe_u32 v38, v0, 1, 2
    v_cmp_eq_u32 vcc, 0, v38
    v_cmp_eq_u32 s[58:59], 1, v38
    s_nop 1
    v_cndmask_b32 v36, 0, v39, vcc
    v_cndmask_b32 v37, 0, v39, s[58:59]
    v_cmp_eq_u32 vcc, 2, v38
    v_cmp_eq_u32 s[58:59], 3, v38
    s_nop 1
    v_cndmask_b32 v38, 0, v39, vcc
    v_cndmask_b32 v39, 0, v39, s[58:59]
    v_mov_b32 v20, 0
    v_mov_b32 v21, 0
    v_mov_b32 v22, 0
    v_mov_b32 v23, 0
    v_mov_b32 v24, 0
    v_mov_b32 v25, 0
    v_mov_b32 v26, 0
    v_mov_b32 v27, 0
    v_mov_b32 v28, 0
    v_mov_b32 v29, 0
    v_mov_b32 v30, 0
    v_mov_b32 v31, 0
    v_mov_b32 v40, 0
    v_mov_b32 v41, 0xff800000
    s_mov_b32 s67, 0x3d93cd3a
    s_mov_b32 s68, 0x3fb8aa3b
    s_cmp_lt_u32 s4, 24
    s_cselect_b32 s49, 32, 0
    s_mov_b32 s43, 1712
    s_mul_i32 s7, s3, 2816
    s_add_u32 s7, s7, 31232
    v_lshrrev_b32 v42, 3, v0
    v_mul_u32_u24 v43, 240, v42
    v_add_u32 v43, s7, v43
    v_bfe_u32 v42, v0, 2, 1
    v_lshl_add_u32 v42, v42, 2, v43
    v_lshl_add_u32 v44, v0, 2, s7
    v_mov_b32 v45, 0xff800000
    ds_write_b32 v44, v45 offset:0
    ds_write_b32 v44, v45 offset:256
    ds_write_b32 v44, v45 offset:512
    ds_write_b32 v44, v45 offset:768
    ds_write_b32 v44, v45 offset:1024
    ds_write_b32 v44, v45 offset:1280
    ds_write_b32 v44, v45 offset:1536
    ds_write_b32 v44, v45 offset:1792
    v_bfe_u32 v17, v0, 4, 1
    v_lshlrev_b32 v17, 3, v17
    v_and_b32 v2, 7, v0
    v_add_u32 v2, v2, v17
    v_lshlrev_b32 v2, 4, v2
    v_lshrrev_b32 v17, 5, v0
    v_mul_u32_u24 v17, 768, v17
    s_mul_i32 s7, s3, 1536
    v_add3_u32 v2, v2, v17, s7
    v_mov_b32 v248, 0
    v_mul_u32_u24 v249, 12, v0
    v_add_u32 v249, 512, v249
    v_add_u32 v250, 1536, v249
    v_add_u32 v251, 3072, v249
    v_add_u32 v252, 4608, v249
    s_lshl_b32 s7, s3, 3
    v_mov_b32 v253, s7
    v_mov_b32 v254, 1
    s_lshl_b32 s94, s2, 10
    s_add_u32 s94, s94, 524288
    s_lshl_b32 s95, s2, 7
    s_add_u32 s95, s95, 786432
    s_waitcnt lgkmcnt(0)
    s_mul_i32 s6, s6, 0x9e3779b1
    s_add_u32 s6, s6, 0x7f4a7c15
    s_and_b32 s56, s2, 3
    s_lshl_b32 s56, s56, 3
    s_lshr_b32 s53, s53, s56
    s_and_b32 s53, s53, 0xff
    s_cmp_lt_u32 s53, 160
    s_cselect_b32 s52, 1, 2
    s_cmp_eq_u32 s53, 255
    s_cselect_b32 s52, 0, s52
    s_cmp_eq_u32 s52, 2
    s_cselect_b32 s56, 4, 0
    s_bitcmp1_b32 s5, 0
    s_cselect_b32 s56, 0, s56
    s_sub_u32 s50, 30, s56
    s_sub_u32 s62, s62, s56
    s_mov_b32 s54, 1
    s_waitcnt vmcnt(9)
    buffer_load_dwordx4 v[72:75], v1, s[8:11], s60 offen offset:0 nt
    buffer_load_dwordx4 v[76:79], v1, s[8:11], s60 offen offset:128 nt
    buffer_load_dwordx4 v[80:83], v1, s[8:11], s60 offen offset:256 nt
    s_waitcnt vmcnt(9)
    buffer_load_dwordx4 v[84:87], v1, s[12:15], s60 offen offset:0 nt
    buffer_load_dwordx4 v[88:91], v1, s[12:15], s60 offen offset:128 nt
    buffer_load_dwordx4 v[92:95], v1, s[12:15], s60 offen offset:256 nt
    s_add_u32 s60, s60, s61
    s_sub_u32 s62, s62, 1
    s_waitcnt vmcnt(9)
    buffer_load_dwordx4 v[96:99], v1, s[8:11], s60 offen offset:0 nt
    buffer_load_dwordx4 v[100:103], v1, s[8:11], s60 offen offset:128 nt
    buffer_load_dwordx4 v[104:107], v1, s[8:11], s60 offen offset:256 nt
    s_waitcnt vmcnt(9)
    buffer_load_dwordx4 v[108:111], v1, s[12:15], s60 offen offset:0 nt
    buffer_load_dwordx4 v[112:115], v1, s[12:15], s60 offen offset:128 nt
    buffer_load_dwordx4 v[116:119], v1, s[12:15], s60 offen offset:256 nt
    s_add_u32 s60, s60, s61
    s_sub_u32 s62, s62, 1
    v_mov_b32 v16, 0
    v_mov_b32 v17, 1
    ds_write_b32 v16, v17 offset:8664
    s_waitcnt vmcnt(9)
    buffer_load_dwordx4 v[120:123], v1, s[8:11], s60 offen offset:0 nt
    buffer_load_dwordx4 v[124:127], v1, s[8:11], s60 offen offset:128 nt
    buffer_load_dwordx4 v[128:131], v1, s[8:11], s60 offen offset:256 nt
    s_waitcnt vmcnt(9)
    buffer_load_dwordx4 v[132:135], v1, s[12:15], s60 offen offset:0 nt
    buffer_load_dwordx4 v[136:139], v1, s[12:15], s60 offen offset:128 nt
    buffer_load_dwordx4 v[140:143], v1, s[12:15], s60 offen offset:256 nt
    s_add_u32 s60, s60, s61
    s_sub_u32 s62, s62, 1
    s_waitcnt vmcnt(9)
    buffer_load_dwordx4 v[144:147], v1, s[8:11], s60 offen offset:0 nt
    buffer_load_dwordx4 v[148:151], v1, s[8:11], s60 offen offset:128 nt
    buffer_load_dwordx4 v[152:155], v1, s[8:11], s60 offen offset:256 nt
    s_waitcnt vmcnt(9)
    buffer_load_dwordx4 v[156:159], v1, s[12:15], s60 offen offset:0 nt
    buffer_load_dwordx4 v[160:163], v1, s[12:15], s60 offen offset:128 nt
    buffer_load_dwordx4 v[164:167], v1, s[12:15], s60 offen offset:256 nt
    s_add_u32 s60, s60, s61
    s_sub_u32 s62, s62, 1
    s_waitcnt vmcnt(9)
    buffer_load_dwordx4 v[168:171], v1, s[8:11], s60 offen offset:0 nt
    buffer_load_dwordx4 v[172:175], v1, s[8:11], s60 offen offset:128 nt
    buffer_load_dwordx4 v[176:179], v1, s[8:11], s60 offen offset:256 nt
    s_waitcnt vmcnt(9)
    buffer_load_dwordx4 v[180:183], v1, s[12:15], s60 offen offset:0 nt
    buffer_load_dwordx4 v[184:187], v1, s[12:15], s60 offen offset:128 nt
    buffer_load_dwordx4 v[188:191], v1, s[12:15], s60 offen offset:256 nt
    s_add_u32 s60, s60, s61
    s_sub_u32 s62, s62, 1
    s_waitcnt vmcnt(9)
    buffer_load_dwordx4 v[192:195], v1, s[8:11], s60 offen offset:0 nt
    buffer_load_dwordx4 v[196:199], v1, s[8:11], s60 offen offset:128 nt
    buffer_load_dwordx4 v[200:203], v1, s[8:11], s60 offen offset:256 nt
    s_waitcnt vmcnt(9)
    buffer_load_dwordx4 v[204:207], v1, s[12:15], s60 offen offset:0 nt
    buffer_load_dwordx4 v[208:211], v1, s[12:15], s60 offen offset:128 nt
    buffer_load_dwordx4 v[212:215], v1, s[12:15], s60 offen offset:256 nt
    s_add_u32 s60, s60, s61
    s_sub_u32 s62, s62, 1
    s_waitcnt vmcnt(9)
    buffer_load_dwordx4 v[216:219], v1, s[8:11], s60 offen offset:0 nt
    buffer_load_dwordx4 v[220:223], v1, s[8:11], s60 offen offset:128 nt
    buffer_load_dwordx4 v[224:227], v1, s[8:11], s60 offen offset:256 nt
    s_waitcnt vmcnt(9)
    buffer_load_dwordx4 v[228:231], v1, s[12:15], s60 offen offset:0 nt
    buffer_load_dwordx4 v[232:235], v1, s[12:15], s60 offen offset:128 nt
    buffer_load_dwordx4 v[236:239], v1, s[12:15], s60 offen offset:256 nt
    s_add_u32 s60, s60, s61
    s_sub_u32 s62, s62, 1
    v_mov_b32 v17, 0
    s_mov_b32 s57, 320000
L_w_2:
    ds_read_b32 v16, v17 offset:8644
    s_sub_u32 s57, s57, 1
    s_waitcnt lgkmcnt(0)
    v_readfirstlane_b32 s7, v16
    s_cmp_eq_u32 s57, 0
    s_cbranch_scc1 L_wok_3
    s_cmp_ge_u32 s7, 1
    s_cbranch_scc1 L_wok_3
    s_sleep 1
    s_branch L_w_2
L_wok_3:
    ds_read_b128 v[4:7], v3 offset:0
    ds_read_b128 v[8:11], v3 offset:128
    ds_read_b128 v[12:15], v3 offset:256
    s_waitcnt lgkmcnt(0)
    s_waitcnt vmcnt(42)
    v_mov_b32 v16, 0
    v_mov_b32 v17, 0
    v_dot2c_f32_bf16 v16, v48, v4
    v_dot2c_f32_bf16 v17, v60, v4
    v_dot2c_f32_bf16 v16, v49, v5
    v_dot2c_f32_bf16 v17, v61, v5
    v_dot2c_f32_bf16 v16, v50, v6
    v_dot2c_f32_bf16 v17, v62, v6
    v_dot2c_f32_bf16 v16, v51, v7
    v_dot2c_f32_bf16 v17, v63, v7
    v_dot2c_f32_bf16 v16, v52, v8
    v_dot2c_f32_bf16 v17, v64, v8
    v_dot2c_f32_bf16 v16, v53, v9
    v_dot2c_f32_bf16 v17, v65, v9
    v_dot2c_f32_bf16 v16, v54, v10
    v_dot2c_f32_bf16 v17, v66, v10
    v_dot2c_f32_bf16 v16, v55, v11
    v_dot2c_f32_bf16 v17, v67, v11
    v_dot2c_f32_bf16 v16, v56, v12
    v_dot2c_f32_bf16 v17, v68, v12
    v_dot2c_f32_bf16 v16, v57, v13
    v_dot2c_f32_bf16 v17, v69, v13
    v_dot2c_f32_bf16 v16, v58, v14
    v_dot2c_f32_bf16 v17, v70, v14
    v_dot2c_f32_bf16 v16, v59, v15
    v_dot2c_f32_bf16 v17, v71, v15
    s_nop 1
    v_add_f32_dpp v16, v16, v16 row_half_mirror row_mask:0xf bank_mask:0x5
    s_nop 0
    v_add_f32_dpp v16, v17, v17 row_half_mirror row_mask:0xf bank_mask:0xa
    s_nop 1
    v_add_f32_dpp v16, v16, v16 quad_perm:[1,0,3,2] row_mask:0xf bank_mask:0xf
    s_nop 1
    v_add_f32_dpp v16, v16, v16 quad_perm:[2,3,0,1] row_mask:0xf bank_mask:0xf
    v_cvt_pk_bf16_f32 v16, v16, v16
    v_lshlrev_b32 v16, 16, v16
    v_mul_f32 v16, s67, v16
    v_cvt_pk_bf16_f32 v16, v16, v16
    v_lshlrev_b32 v16, 16, v16
    v_max_f32 v41, v41, v16
    ds_write_b32 v42, v16
    v_add_u32 v42, 8, v42
    buffer_load_dwordx4 v[48:51], v1, s[8:11], s60 offen offset:0 nt
    buffer_load_dwordx4 v[52:55], v1, s[8:11], s60 offen offset:128 nt
    buffer_load_dwordx4 v[56:59], v1, s[8:11], s60 offen offset:256 nt
    buffer_load_dwordx4 v[60:63], v1, s[12:15], s60 offen offset:0 nt
    buffer_load_dwordx4 v[64:67], v1, s[12:15], s60 offen offset:128 nt
    buffer_load_dwordx4 v[68:71], v1, s[12:15], s60 offen offset:256 nt
    s_add_u32 s60, s60, s61
    s_sub_u32 s62, s62, 1
    s_waitcnt vmcnt(42)
    v_mov_b32 v16, 0
    v_mov_b32 v17, 0
    v_dot2c_f32_bf16 v16, v72, v4
    v_dot2c_f32_bf16 v17, v84, v4
    v_dot2c_f32_bf16 v16, v73, v5
    v_dot2c_f32_bf16 v17, v85, v5
    v_dot2c_f32_bf16 v16, v74, v6
    v_dot2c_f32_bf16 v17, v86, v6
    v_dot2c_f32_bf16 v16, v75, v7
    v_dot2c_f32_bf16 v17, v87, v7
    v_dot2c_f32_bf16 v16, v76, v8
    v_dot2c_f32_bf16 v17, v88, v8
    v_dot2c_f32_bf16 v16, v77, v9
    v_dot2c_f32_bf16 v17, v89, v9
    v_dot2c_f32_bf16 v16, v78, v10
    v_dot2c_f32_bf16 v17, v90, v10
    v_dot2c_f32_bf16 v16, v79, v11
    v_dot2c_f32_bf16 v17, v91, v11
    v_dot2c_f32_bf16 v16, v80, v12
    v_dot2c_f32_bf16 v17, v92, v12
    v_dot2c_f32_bf16 v16, v81, v13
    v_dot2c_f32_bf16 v17, v93, v13
    v_dot2c_f32_bf16 v16, v82, v14
    v_dot2c_f32_bf16 v17, v94, v14
    v_dot2c_f32_bf16 v16, v83, v15
    v_dot2c_f32_bf16 v17, v95, v15
    s_nop 1
    v_add_f32_dpp v16, v16, v16 row_half_mirror row_mask:0xf bank_mask:0x5
    s_nop 0
    v_add_f32_dpp v16, v17, v17 row_half_mirror row_mask:0xf bank_mask:0xa
    s_nop 1
    v_add_f32_dpp v16, v16, v16 quad_perm:[1,0,3,2] row_mask:0xf bank_mask:0xf
    s_nop 1
    v_add_f32_dpp v16, v16, v16 quad_perm:[2,3,0,1] row_mask:0xf bank_mask:0xf
    v_cvt_pk_bf16_f32 v16, v16, v16
    v_lshlrev_b32 v16, 16, v16
    v_mul_f32 v16, s67, v16
    v_cvt_pk_bf16_f32 v16, v16, v16
    v_lshlrev_b32 v16, 16, v16
    v_max_f32 v41, v41, v16
    ds_write_b32 v42, v16
    v_add_u32 v42, 8, v42
    buffer_load_dwordx4 v[72:75], v1, s[8:11], s60 offen offset:0 nt
    buffer_load_dwordx4 v[76:79], v1, s[8:11], s60 offen offset:128 nt
    buffer_load_dwordx4 v[80:83], v1, s[8:11], s60 offen offset:256 nt
    buffer_load_dwordx4 v[84:87], v1, s[12:15], s60 offen offset:0 nt
    buffer_load_dwordx4 v[88:91], v1, s[12:15], s60 offen offset:128 nt
    buffer_load_dwordx4 v[92:95], v1, s[12:15], s60 offen offset:256 nt
    s_add_u32 s60, s60, s61
    s_sub_u32 s62, s62, 1
    s_waitcnt vmcnt(42)
    v_mov_b32 v16, 0
    v_mov_b32 v17, 0
    v_dot2c_f32_bf16 v16, v96, v4
    v_dot2c_f32_bf16 v17, v108, v4
    v_dot2c_f32_bf16 v16, v97, v5
    v_dot2c_f32_bf16 v17, v109, v5
    v_dot2c_f32_bf16 v16, v98, v6
    v_dot2c_f32_bf16 v17, v110, v6
    v_dot2c_f32_bf16 v16, v99, v7
    v_dot2c_f32_bf16 v17, v111, v7
    v_dot2c_f32_bf16 v16, v100, v8
    v_dot2c_f32_bf16 v17, v112, v8
    v_dot2c_f32_bf16 v16, v101, v9
    v_dot2c_f32_bf16 v17, v113, v9
    v_dot2c_f32_bf16 v16, v102, v10
    v_dot2c_f32_bf16 v17, v114, v10
    v_dot2c_f32_bf16 v16, v103, v11
    v_dot2c_f32_bf16 v17, v115, v11
    v_dot2c_f32_bf16 v16, v104, v12
    v_dot2c_f32_bf16 v17, v116, v12
    v_dot2c_f32_bf16 v16, v105, v13
    v_dot2c_f32_bf16 v17, v117, v13
    v_dot2c_f32_bf16 v16, v106, v14
    v_dot2c_f32_bf16 v17, v118, v14
    v_dot2c_f32_bf16 v16, v107, v15
    v_dot2c_f32_bf16 v17, v119, v15
    s_nop 1
    v_add_f32_dpp v16, v16, v16 row_half_mirror row_mask:0xf bank_mask:0x5
    s_nop 0
    v_add_f32_dpp v16, v17, v17 row_half_mirror row_mask:0xf bank_mask:0xa
    s_nop 1
    v_add_f32_dpp v16, v16, v16 quad_perm:[1,0,3,2] row_mask:0xf bank_mask:0xf
    s_nop 1
    v_add_f32_dpp v16, v16, v16 quad_perm:[2,3,0,1] row_mask:0xf bank_mask:0xf
    v_cvt_pk_bf16_f32 v16, v16, v16
    v_lshlrev_b32 v16, 16, v16
    v_mul_f32 v16, s67, v16
    v_cvt_pk_bf16_f32 v16, v16, v16
    v_lshlrev_b32 v16, 16, v16
    v_max_f32 v41, v41, v16
    ds_write_b32 v42, v16
    v_add_u32 v42, 8, v42
    buffer_load_dwordx4 v[96:99], v1, s[8:11], s60 offen offset:0 nt
    buffer_load_dwordx4 v[100:103], v1, s[8:11], s60 offen offset:128 nt
    buffer_load_dwordx4 v[104:107], v1, s[8:11], s60 offen offset:256 nt
    buffer_load_dwordx4 v[108:111], v1, s[12:15], s60 offen offset:0 nt
    buffer_load_dwordx4 v[112:115], v1, s[12:15], s60 offen offset:128 nt
    buffer_load_dwordx4 v[116:119], v1, s[12:15], s60 offen offset:256 nt
    s_add_u32 s60, s60, s61
    s_sub_u32 s62, s62, 1
    s_waitcnt vmcnt(42)
    v_mov_b32 v16, 0
    v_mov_b32 v17, 0
    v_dot2c_f32_bf16 v16, v120, v4
    v_dot2c_f32_bf16 v17, v132, v4
    v_dot2c_f32_bf16 v16, v121, v5
    v_dot2c_f32_bf16 v17, v133, v5
    v_dot2c_f32_bf16 v16, v122, v6
    v_dot2c_f32_bf16 v17, v134, v6
    v_dot2c_f32_bf16 v16, v123, v7
    v_dot2c_f32_bf16 v17, v135, v7
    v_dot2c_f32_bf16 v16, v124, v8
    v_dot2c_f32_bf16 v17, v136, v8
    v_dot2c_f32_bf16 v16, v125, v9
    v_dot2c_f32_bf16 v17, v137, v9
    v_dot2c_f32_bf16 v16, v126, v10
    v_dot2c_f32_bf16 v17, v138, v10
    v_dot2c_f32_bf16 v16, v127, v11
    v_dot2c_f32_bf16 v17, v139, v11
    v_dot2c_f32_bf16 v16, v128, v12
    v_dot2c_f32_bf16 v17, v140, v12
    v_dot2c_f32_bf16 v16, v129, v13
    v_dot2c_f32_bf16 v17, v141, v13
    v_dot2c_f32_bf16 v16, v130, v14
    v_dot2c_f32_bf16 v17, v142, v14
    v_dot2c_f32_bf16 v16, v131, v15
    v_dot2c_f32_bf16 v17, v143, v15
    s_nop 1
    v_add_f32_dpp v16, v16, v16 row_half_mirror row_mask:0xf bank_mask:0x5
    s_nop 0
    v_add_f32_dpp v16, v17, v17 row_half_mirror row_mask:0xf bank_mask:0xa
    s_nop 1
    v_add_f32_dpp v16, v16, v16 quad_perm:[1,0,3,2] row_mask:0xf bank_mask:0xf
    s_nop 1
    v_add_f32_dpp v16, v16, v16 quad_perm:[2,3,0,1] row_mask:0xf bank_mask:0xf
    v_cvt_pk_bf16_f32 v16, v16, v16
    v_lshlrev_b32 v16, 16, v16
    v_mul_f32 v16, s67, v16
    v_cvt_pk_bf16_f32 v16, v16, v16
    v_lshlrev_b32 v16, 16, v16
    v_max_f32 v41, v41, v16
    ds_write_b32 v42, v16
    v_add_u32 v42, 8, v42
    buffer_load_dwordx4 v[120:123], v1, s[8:11], s60 offen offset:0 nt
    buffer_load_dwordx4 v[124:127], v1, s[8:11], s60 offen offset:128 nt
    buffer_load_dwordx4 v[128:131], v1, s[8:11], s60 offen offset:256 nt
    buffer_load_dwordx4 v[132:135], v1, s[12:15], s60 offen offset:0 nt
    buffer_load_dwordx4 v[136:139], v1, s[12:15], s60 offen offset:128 nt
    buffer_load_dwordx4 v[140:143], v1, s[12:15], s60 offen offset:256 nt
    s_add_u32 s60, s60, s61
    s_sub_u32 s62, s62, 1
    s_waitcnt vmcnt(42)
    v_mov_b32 v16, 0
    v_mov_b32 v17, 0
    v_dot2c_f32_bf16 v16, v144, v4
    v_dot2c_f32_bf16 v17, v156, v4
    v_dot2c_f32_bf16 v16, v145, v5
    v_dot2c_f32_bf16 v17, v157, v5
    v_dot2c_f32_bf16 v16, v146, v6
    v_dot2c_f32_bf16 v17, v158, v6
    v_dot2c_f32_bf16 v16, v147, v7
    v_dot2c_f32_bf16 v17, v159, v7
    v_dot2c_f32_bf16 v16, v148, v8
    v_dot2c_f32_bf16 v17, v160, v8
    v_dot2c_f32_bf16 v16, v149, v9
    v_dot2c_f32_bf16 v17, v161, v9
    v_dot2c_f32_bf16 v16, v150, v10
    v_dot2c_f32_bf16 v17, v162, v10
    v_dot2c_f32_bf16 v16, v151, v11
    v_dot2c_f32_bf16 v17, v163, v11
    v_dot2c_f32_bf16 v16, v152, v12
    v_dot2c_f32_bf16 v17, v164, v12
    v_dot2c_f32_bf16 v16, v153, v13
    v_dot2c_f32_bf16 v17, v165, v13
    v_dot2c_f32_bf16 v16, v154, v14
    v_dot2c_f32_bf16 v17, v166, v14
    v_dot2c_f32_bf16 v16, v155, v15
    v_dot2c_f32_bf16 v17, v167, v15
    s_nop 1
    v_add_f32_dpp v16, v16, v16 row_half_mirror row_mask:0xf bank_mask:0x5
    s_nop 0
    v_add_f32_dpp v16, v17, v17 row_half_mirror row_mask:0xf bank_mask:0xa
    s_nop 1
    v_add_f32_dpp v16, v16, v16 quad_perm:[1,0,3,2] row_mask:0xf bank_mask:0xf
    s_nop 1
    v_add_f32_dpp v16, v16, v16 quad_perm:[2,3,0,1] row_mask:0xf bank_mask:0xf
    v_cvt_pk_bf16_f32 v16, v16, v16
    v_lshlrev_b32 v16, 16, v16
    v_mul_f32 v16, s67, v16
    v_cvt_pk_bf16_f32 v16, v16, v16
    v_lshlrev_b32 v16, 16, v16
    v_max_f32 v41, v41, v16
    ds_write_b32 v42, v16
    v_add_u32 v42, 8, v42
    s_waitcnt vmcnt(36)
    v_mov_b32 v16, 0
    v_mov_b32 v17, 0
    v_dot2c_f32_bf16 v16, v168, v4
    v_dot2c_f32_bf16 v17, v180, v4
    v_dot2c_f32_bf16 v16, v169, v5
    v_dot2c_f32_bf16 v17, v181, v5
    v_dot2c_f32_bf16 v16, v170, v6
    v_dot2c_f32_bf16 v17, v182, v6
    v_dot2c_f32_bf16 v16, v171, v7
    v_dot2c_f32_bf16 v17, v183, v7
    v_dot2c_f32_bf16 v16, v172, v8
    v_dot2c_f32_bf16 v17, v184, v8
    v_dot2c_f32_bf16 v16, v173, v9
    v_dot2c_f32_bf16 v17, v185, v9
    v_dot2c_f32_bf16 v16, v174, v10
    v_dot2c_f32_bf16 v17, v186, v10
    v_dot2c_f32_bf16 v16, v175, v11
    v_dot2c_f32_bf16 v17, v187, v11
    v_dot2c_f32_bf16 v16, v176, v12
    v_dot2c_f32_bf16 v17, v188, v12
    v_dot2c_f32_bf16 v16, v177, v13
    v_dot2c_f32_bf16 v17, v189, v13
    v_dot2c_f32_bf16 v16, v178, v14
    v_dot2c_f32_bf16 v17, v190, v14
    v_dot2c_f32_bf16 v16, v179, v15
    v_dot2c_f32_bf16 v17, v191, v15
    s_nop 1
    v_add_f32_dpp v16, v16, v16 row_half_mirror row_mask:0xf bank_mask:0x5
    s_nop 0
    v_add_f32_dpp v16, v17, v17 row_half_mirror row_mask:0xf bank_mask:0xa
    s_nop 1
    v_add_f32_dpp v16, v16, v16 quad_perm:[1,0,3,2] row_mask:0xf bank_mask:0xf
    s_nop 1
    v_add_f32_dpp v16, v16, v16 quad_perm:[2,3,0,1] row_mask:0xf bank_mask:0xf
    v_cvt_pk_bf16_f32 v16, v16, v16
    v_lshlrev_b32 v16, 16, v16
    v_mul_f32 v16, s67, v16
    v_cvt_pk_bf16_f32 v16, v16, v16
    v_lshlrev_b32 v16, 16, v16
    v_max_f32 v41, v41, v16
    ds_write_b32 v42, v16
    v_add_u32 v42, 8, v42
    s_waitcnt vmcnt(30)
    v_mov_b32 v16, 0
    v_mov_b32 v17, 0
    v_dot2c_f32_bf16 v16, v192, v4
    v_dot2c_f32_bf16 v17, v204, v4
    v_dot2c_f32_bf16 v16, v193, v5
    v_dot2c_f32_bf16 v17, v205, v5
    v_dot2c_f32_bf16 v16, v194, v6
    v_dot2c_f32_bf16 v17, v206, v6
    v_dot2c_f32_bf16 v16, v195, v7
    v_dot2c_f32_bf16 v17, v207, v7
    v_dot2c_f32_bf16 v16, v196, v8
    v_dot2c_f32_bf16 v17, v208, v8
    v_dot2c_f32_bf16 v16, v197, v9
    v_dot2c_f32_bf16 v17, v209, v9
    v_dot2c_f32_bf16 v16, v198, v10
    v_dot2c_f32_bf16 v17, v210, v10
    v_dot2c_f32_bf16 v16, v199, v11
    v_dot2c_f32_bf16 v17, v211, v11
    v_dot2c_f32_bf16 v16, v200, v12
    v_dot2c_f32_bf16 v17, v212, v12
    v_dot2c_f32_bf16 v16, v201, v13
    v_dot2c_f32_bf16 v17, v213, v13
    v_dot2c_f32_bf16 v16, v202, v14
    v_dot2c_f32_bf16 v17, v214, v14
    v_dot2c_f32_bf16 v16, v203, v15
    v_dot2c_f32_bf16 v17, v215, v15
    s_nop 1
    v_add_f32_dpp v16, v16, v16 row_half_mirror row_mask:0xf bank_mask:0x5
    s_nop 0
    v_add_f32_dpp v16, v17, v17 row_half_mirror row_mask:0xf bank_mask:0xa
    s_nop 1
    v_add_f32_dpp v16, v16, v16 quad_perm:[1,0,3,2] row_mask:0xf bank_mask:0xf
    s_nop 1
    v_add_f32_dpp v16, v16, v16 quad_perm:[2,3,0,1] row_mask:0xf bank_mask:0xf
    v_cvt_pk_bf16_f32 v16, v16, v16
    v_lshlrev_b32 v16, 16, v16
    v_mul_f32 v16, s67, v16
    v_cvt_pk_bf16_f32 v16, v16, v16
    v_lshlrev_b32 v16, 16, v16
    v_max_f32 v41, v41, v16
    ds_write_b32 v42, v16
    v_add_u32 v42, 8, v42
    s_waitcnt vmcnt(24)
    v_mov_b32 v16, 0
    v_mov_b32 v17, 0
    v_dot2c_f32_bf16 v16, v216, v4
    v_dot2c_f32_bf16 v17, v228, v4
    v_dot2c_f32_bf16 v16, v217, v5
    v_dot2c_f32_bf16 v17, v229, v5
    v_dot2c_f32_bf16 v16, v218, v6
    v_dot2c_f32_bf16 v17, v230, v6
    v_dot2c_f32_bf16 v16, v219, v7
    v_dot2c_f32_bf16 v17, v231, v7
    v_dot2c_f32_bf16 v16, v220, v8
    v_dot2c_f32_bf16 v17, v232, v8
    v_dot2c_f32_bf16 v16, v221, v9
    v_dot2c_f32_bf16 v17, v233, v9
    v_dot2c_f32_bf16 v16, v222, v10
    v_dot2c_f32_bf16 v17, v234, v10
    v_dot2c_f32_bf16 v16, v223, v11
    v_dot2c_f32_bf16 v17, v235, v11
    v_dot2c_f32_bf16 v16, v224, v12
    v_dot2c_f32_bf16 v17, v236, v12
    v_dot2c_f32_bf16 v16, v225, v13
    v_dot2c_f32_bf16 v17, v237, v13
    v_dot2c_f32_bf16 v16, v226, v14
    v_dot2c_f32_bf16 v17, v238, v14
    v_dot2c_f32_bf16 v16, v227, v15
    v_dot2c_f32_bf16 v17, v239, v15
    s_nop 1
    v_add_f32_dpp v16, v16, v16 row_half_mirror row_mask:0xf bank_mask:0x5
    s_nop 0
    v_add_f32_dpp v16, v17, v17 row_half_mirror row_mask:0xf bank_mask:0xa
    s_nop 1
    v_add_f32_dpp v16, v16, v16 quad_perm:[1,0,3,2] row_mask:0xf bank_mask:0xf
    s_nop 1
    v_add_f32_dpp v16, v16, v16 quad_perm:[2,3,0,1] row_mask:0xf bank_mask:0xf
    v_cvt_pk_bf16_f32 v16, v16, v16
    v_lshlrev_b32 v16, 16, v16
    v_mul_f32 v16, s67, v16
    v_cvt_pk_bf16_f32 v16, v16, v16
    v_lshlrev_b32 v16, 16, v16
    v_max_f32 v41, v41, v16
    ds_write_b32 v42, v16
    v_add_u32 v42, 8, v42
    s_waitcnt vmcnt(18)
    v_mov_b32 v16, 0
    v_mov_b32 v17, 0
    v_dot2c_f32_bf16 v16, v48, v4
    v_dot2c_f32_bf16 v17, v60, v4
    v_dot2c_f32_bf16 v16, v49, v5
    v_dot2c_f32_bf16 v17, v61, v5
    v_dot2c_f32_bf16 v16, v50, v6
    v_dot2c_f32_bf16 v17, v62, v6
    v_dot2c_f32_bf16 v16, v51, v7
    v_dot2c_f32_bf16 v17, v63, v7
    v_dot2c_f32_bf16 v16, v52, v8
    v_dot2c_f32_bf16 v17, v64, v8
    v_dot2c_f32_bf16 v16, v53, v9
    v_dot2c_f32_bf16 v17, v65, v9
    v_dot2c_f32_bf16 v16, v54, v10
    v_dot2c_f32_bf16 v17, v66, v10
    v_dot2c_f32_bf16 v16, v55, v11
    v_dot2c_f32_bf16 v17, v67, v11
    v_dot2c_f32_bf16 v16, v56, v12
    v_dot2c_f32_bf16 v17, v68, v12
    v_dot2c_f32_bf16 v16, v57, v13
    v_dot2c_f32_bf16 v17, v69, v13
    v_dot2c_f32_bf16 v16, v58, v14
    v_dot2c_f32_bf16 v17, v70, v14
    v_dot2c_f32_bf16 v16, v59, v15
    v_dot2c_f32_bf16 v17, v71, v15
    s_nop 1
    v_add_f32_dpp v16, v16, v16 row_half_mirror row_mask:0xf bank_mask:0x5
    s_nop 0
    v_add_f32_dpp v16, v17, v17 row_half_mirror row_mask:0xf bank_mask:0xa
    s_nop 1
    v_add_f32_dpp v16, v16, v16 quad_perm:[1,0,3,2] row_mask:0xf bank_mask:0xf
    s_nop 1
    v_add_f32_dpp v16, v16, v16 quad_perm:[2,3,0,1] row_mask:0xf bank_mask:0xf
    v_cvt_pk_bf16_f32 v16, v16, v16
    v_lshlrev_b32 v16, 16, v16
    v_mul_f32 v16, s67, v16
    v_cvt_pk_bf16_f32 v16, v16, v16
    v_lshlrev_b32 v16, 16, v16
    v_max_f32 v41, v41, v16
    ds_write_b32 v42, v16
    v_add_u32 v42, 8, v42
    s_waitcnt vmcnt(12)
    v_mov_b32 v16, 0
    v_mov_b32 v17, 0
    v_dot2c_f32_bf16 v16, v72, v4
    v_dot2c_f32_bf16 v17, v84, v4
    v_dot2c_f32_bf16 v16, v73, v5
    v_dot2c_f32_bf16 v17, v85, v5
    v_dot2c_f32_bf16 v16, v74, v6
    v_dot2c_f32_bf16 v17, v86, v6
    v_dot2c_f32_bf16 v16, v75, v7
    v_dot2c_f32_bf16 v17, v87, v7
    v_dot2c_f32_bf16 v16, v76, v8
    v_dot2c_f32_bf16 v17, v88, v8
    v_dot2c_f32_bf16 v16, v77, v9
    v_dot2c_f32_bf16 v17, v89, v9
    v_dot2c_f32_bf16 v16, v78, v10
    v_dot2c_f32_bf16 v17, v90, v10
    v_dot2c_f32_bf16 v16, v79, v11
    v_dot2c_f32_bf16 v17, v91, v11
    v_dot2c_f32_bf16 v16, v80, v12
    v_dot2c_f32_bf16 v17, v92, v12
    v_dot2c_f32_bf16 v16, v81, v13
    v_dot2c_f32_bf16 v17, v93, v13
    v_dot2c_f32_bf16 v16, v82, v14
    v_dot2c_f32_bf16 v17, v94, v14
    v_dot2c_f32_bf16 v16, v83, v15
    v_dot2c_f32_bf16 v17, v95, v15
    s_nop 1
    v_add_f32_dpp v16, v16, v16 row_half_mirror row_mask:0xf bank_mask:0x5
    s_nop 0
    v_add_f32_dpp v16, v17, v17 row_half_mirror row_mask:0xf bank_mask:0xa
    s_nop 1
    v_add_f32_dpp v16, v16, v16 quad_perm:[1,0,3,2] row_mask:0xf bank_mask:0xf
    s_nop 1
    v_add_f32_dpp v16, v16, v16 quad_perm:[2,3,0,1] row_mask:0xf bank_mask:0xf
    v_cvt_pk_bf16_f32 v16, v16, v16
    v_lshlrev_b32 v16, 16, v16
    v_mul_f32 v16, s67, v16
    v_cvt_pk_bf16_f32 v16, v16, v16
    v_lshlrev_b32 v16, 16, v16
    v_max_f32 v41, v41, v16
    ds_write_b32 v42, v16
    v_add_u32 v42, 8, v42
    s_sub_u32 s55, s50, 10
L_kloop:
    s_waitcnt vmcnt(6)
    v_mov_b32 v16, 0
    v_mov_b32 v17, 0
    v_dot2c_f32_bf16 v16, v96, v4
    v_dot2c_f32_bf16 v17, v108, v4
    v_dot2c_f32_bf16 v16, v97, v5
    v_dot2c_f32_bf16 v17, v109, v5
    v_dot2c_f32_bf16 v16, v98, v6
    v_dot2c_f32_bf16 v17, v110, v6
    v_dot2c_f32_bf16 v16, v99, v7
    v_dot2c_f32_bf16 v17, v111, v7
    v_dot2c_f32_bf16 v16, v100, v8
    v_dot2c_f32_bf16 v17, v112, v8
    v_dot2c_f32_bf16 v16, v101, v9
    v_dot2c_f32_bf16 v17, v113, v9
    v_dot2c_f32_bf16 v16, v102, v10
    v_dot2c_f32_bf16 v17, v114, v10
    v_dot2c_f32_bf16 v16, v103, v11
    v_dot2c_f32_bf16 v17, v115, v11
    v_dot2c_f32_bf16 v16, v104, v12
    v_dot2c_f32_bf16 v17, v116, v12
    v_dot2c_f32_bf16 v16, v105, v13
    v_dot2c_f32_bf16 v17, v117, v13
    v_dot2c_f32_bf16 v16, v106, v14
    v_dot2c_f32_bf16 v17, v118, v14
    v_dot2c_f32_bf16 v16, v107, v15
    v_dot2c_f32_bf16 v17, v119, v15
    s_nop 1
    v_add_f32_dpp v16, v16, v16 row_half_mirror row_mask:0xf bank_mask:0x5
    s_nop 0
    v_add_f32_dpp v16, v17, v17 row_half_mirror row_mask:0xf bank_mask:0xa
    s_nop 1
    v_add_f32_dpp v16, v16, v16 quad_perm:[1,0,3,2] row_mask:0xf bank_mask:0xf
    s_nop 1
    v_add_f32_dpp v16, v16, v16 quad_perm:[2,3,0,1] row_mask:0xf bank_mask:0xf
    v_cvt_pk_bf16_f32 v16, v16, v16
    v_lshlrev_b32 v16, 16, v16
    v_mul_f32 v16, s67, v16
    v_cvt_pk_bf16_f32 v16, v16, v16
    v_lshlrev_b32 v16, 16, v16
    v_max_f32 v41, v41, v16
    ds_write_b32 v42, v16
    v_add_u32 v42, 8, v42
    s_cmp_lg_u32 s62, 0
    s_cbranch_scc1 L_k_4
    s_mov_b32 s8, s20
    s_mov_b32 s9, s21
    s_add_u32 s12, s20, 3072
    s_addc_u32 s13, s21, 0
    s_mov_b32 s60, s48
    s_mov_b32 s62, s50
L_k_4:
    s_waitcnt vmcnt(2)
    buffer_load_dwordx4 v[96:99], v1, s[8:11], s60 offen offset:0 nt
    buffer_load_dwordx4 v[100:103], v1, s[8:11], s60 offen offset:128 nt
    buffer_load_dwordx4 v[104:107], v1, s[8:11], s60 offen offset:256 nt
    buffer_load_dwordx4 v[108:111], v1, s[12:15], s60 offen offset:0 nt
    buffer_load_dwordx4 v[112:115], v1, s[12:15], s60 offen offset:128 nt
    buffer_load_dwordx4 v[116:119], v1, s[12:15], s60 offen offset:256 nt
    s_add_u32 s60, s60, s61
    s_sub_u32 s62, s62, 1
    s_waitcnt vmcnt(6)
    v_mov_b32 v16, 0
    v_mov_b32 v17, 0
    v_dot2c_f32_bf16 v16, v120, v4
    v_dot2c_f32_bf16 v17, v132, v4
    v_dot2c_f32_bf16 v16, v121, v5
    v_dot2c_f32_bf16 v17, v133, v5
    v_dot2c_f32_bf16 v16, v122, v6
    v_dot2c_f32_bf16 v17, v134, v6
    v_dot2c_f32_bf16 v16, v123, v7
    v_dot2c_f32_bf16 v17, v135, v7
    v_dot2c_f32_bf16 v16, v124, v8
    v_dot2c_f32_bf16 v17, v136, v8
    v_dot2c_f32_bf16 v16, v125, v9
    v_dot2c_f32_bf16 v17, v137, v9
    v_dot2c_f32_bf16 v16, v126, v10
    v_dot2c_f32_bf16 v17, v138, v10
    v_dot2c_f32_bf16 v16, v127, v11
    v_dot2c_f32_bf16 v17, v139, v11
    v_dot2c_f32_bf16 v16, v128, v12
    v_dot2c_f32_bf16 v17, v140, v12
    v_dot2c_f32_bf16 v16, v129, v13
    v_dot2c_f32_bf16 v17, v141, v13
    v_dot2c_f32_bf16 v16, v130, v14
    v_dot2c_f32_bf16 v17, v142, v14
    v_dot2c_f32_bf16 v16, v131, v15
    v_dot2c_f32_bf16 v17, v143, v15
    s_nop 1
    v_add_f32_dpp v16, v16, v16 row_half_mirror row_mask:0xf bank_mask:0x5
    s_nop 0
    v_add_f32_dpp v16, v17, v17 row_half_mirror row_mask:0xf bank_mask:0xa
    s_nop 1
    v_add_f32_dpp v16, v16, v16 quad_perm:[1,0,3,2] row_mask:0xf bank_mask:0xf
    s_nop 1
    v_add_f32_dpp v16, v16, v16 quad_perm:[2,3,0,1] row_mask:0xf bank_mask:0xf
    v_cvt_pk_bf16_f32 v16, v16, v16
    v_lshlrev_b32 v16, 16, v16
    v_mul_f32 v16, s67, v16
    v_cvt_pk_bf16_f32 v16, v16, v16
    v_lshlrev_b32 v16, 16, v16
    v_max_f32 v41, v41, v16
    ds_write_b32 v42, v16
    v_add_u32 v42, 8, v42
    s_cmp_lg_u32 s62, 0
    s_cbranch_scc1 L_k_7
    s_mov_b32 s8, s20
    s_mov_b32 s9, s21
    s_add_u32 s12, s20, 3072
    s_addc_u32 s13, s21, 0
    s_mov_b32 s60, s48
    s_mov_b32 s62, s50
L_k_7:
    s_waitcnt vmcnt(2)
    buffer_load_dwordx4 v[120:123], v1, s[8:11], s60 offen offset:0 nt
    buffer_load_dwordx4 v[124:127], v1, s[8:11], s60 offen offset:128 nt
    buffer_load_dwordx4 v[128:131], v1, s[8:11], s60 offen offset:256 nt
    buffer_load_dwordx4 v[132:135], v1, s[12:15], s60 offen offset:0 nt
    buffer_load_dwordx4 v[136:139], v1, s[12:15], s60 offen offset:128 nt
    buffer_load_dwordx4 v[140:143], v1, s[12:15], s60 offen offset:256 nt
    s_add_u32 s60, s60, s61
    s_sub_u32 s62, s62, 1
    s_sub_u32 s55, s55, 2
    s_cmp_lg_u32 s55, 0
    s_cbranch_scc1 L_kloop
    s_nop 1
    v_max_f32_dpp v41, v41, v41 row_half_mirror row_mask:0xf bank_mask:0xf
    s_nop 1
    v_max_f32_dpp v41, v41, v41 row_mirror row_mask:0xf bank_mask:0xf
    s_nop 1
    v_max_f32_dpp v41, v41, v41 row_bcast:15 row_mask:0xa bank_mask:0xf
    s_nop 1
    v_max_f32_dpp v41, v41, v41 row_bcast:31 row_mask:0xc bank_mask:0xf
    s_waitcnt lgkmcnt(0)
    ds_read_b32 v144, v44 offset:0
    ds_read_b32 v145, v44 offset:256
    ds_read_b32 v146, v44 offset:512
    ds_read_b32 v147, v44 offset:768
    ds_read_b32 v148, v44 offset:1024
    ds_read_b32 v149, v44 offset:1280
    ds_read_b32 v150, v44 offset:1536
    ds_read_b32 v151, v44 offset:1792
    v_readlane_b32 s7, v41, 63
    s_nop 1
    v_mov_b32 v41, s7
    s_waitcnt lgkmcnt(0)
    v_cmp_gt_u32 vcc, 32, v0
    s_nop 1
    v_cndmask_b32 v151, v45, v151, vcc
    v_sub_f32 v144, v144, v41
    v_mul_f32 v144, s68, v144
    v_exp_f32 v144, v144
    v_sub_f32 v145, v145, v41
    v_mul_f32 v145, s68, v145
    v_exp_f32 v145, v145
    v_sub_f32 v146, v146, v41
    v_mul_f32 v146, s68, v146
    v_exp_f32 v146, v146
    v_sub_f32 v147, v147, v41
    v_mul_f32 v147, s68, v147
    v_exp_f32 v147, v147
    v_sub_f32 v148, v148, v41
    v_mul_f32 v148, s68, v148
    v_exp_f32 v148, v148
    v_sub_f32 v149, v149, v41
    v_mul_f32 v149, s68, v149
    v_exp_f32 v149, v149
    v_sub_f32 v150, v150, v41
    v_mul_f32 v150, s68, v150
    v_exp_f32 v150, v150
    v_sub_f32 v151, v151, v41
    v_mul_f32 v151, s68, v151
    v_exp_f32 v151, v151
    v_add_f32 v40, v40, v144
    v_cvt_pk_bf16_f32 v144, v144, v144
    ds_write_b32 v44, v144 offset:0
    v_add_f32 v40, v40, v145
    v_cvt_pk_bf16_f32 v145, v145, v145
    ds_write_b32 v44, v145 offset:256
    v_add_f32 v40, v40, v146
    v_cvt_pk_bf16_f32 v146, v146, v146
    ds_write_b32 v44, v146 offset:512
    v_add_f32 v40, v40, v147
    v_cvt_pk_bf16_f32 v147, v147, v147
    ds_write_b32 v44, v147 offset:768
    v_add_f32 v40, v40, v148
    v_cvt_pk_bf16_f32 v148, v148, v148
    ds_write_b32 v44, v148 offset:1024
    v_add_f32 v40, v40, v149
    v_cvt_pk_bf16_f32 v149, v149, v149
    ds_write_b32 v44, v149 offset:1280
    v_add_f32 v40, v40, v150
    v_cvt_pk_bf16_f32 v150, v150, v150
    ds_write_b32 v44, v150 offset:1536
    v_add_f32 v40, v40, v151
    v_cvt_pk_bf16_f32 v151, v151, v151
    ds_write_b32 v44, v151 offset:1792
    s_nop 1
    v_add_f32_dpp v40, v40, v40 quad_perm:[1,0,3,2] row_mask:0xf bank_mask:0xf
    s_nop 1
    v_add_f32_dpp v40, v40, v40 quad_perm:[2,3,0,1] row_mask:0xf bank_mask:0xf
    s_nop 1
    v_add_f32_dpp v40, v40, v40 row_half_mirror row_mask:0xf bank_mask:0xf
    s_waitcnt lgkmcnt(0)
    s_mov_b32 s55, s50
    v_mov_b32 v44, 0
    v_mov_b32 v45, 1
L_vloop:
    ds_read_b64 v[46:47], v43
    v_add_u32 v43, 8, v43
    s_waitcnt vmcnt(6) lgkmcnt(0)
    v_and_b32 v32, v46, v36
    v_and_b32 v33, v46, v37
    v_and_b32 v34, v46, v38
    v_and_b32 v35, v46, v39
    v_and_b32 v16, v47, v36
    v_and_b32 v17, v47, v37
    v_mfma_f32_16x16x32_bf16 v[20:23], v[96:99], v[32:35], v[20:23]
    v_mfma_f32_16x16x32_bf16 v[24:27], v[100:103], v[32:35], v[24:27]
    v_mfma_f32_16x16x32_bf16 v[28:31], v[104:107], v[32:35], v[28:31]
    v_and_b32 v18, v47, v38
    v_and_b32 v19, v47, v39
    s_nop 1
    v_mfma_f32_16x16x32_bf16 v[20:23], v[108:111], v[16:19], v[20:23]
    v_mfma_f32_16x16x32_bf16 v[24:27], v[112:115], v[16:19], v[24:27]
    v_mfma_f32_16x16x32_bf16 v[28:31], v[116:119], v[16:19], v[28:31]
    s_cmp_lg_u32 s62, 0
    s_cbranch_scc1 L_n_10
    s_mov_b32 s66, 1
    s_atomic_add s66, s[64:65], 0x0 glc
    s_waitcnt vmcnt(2)
    s_waitcnt lgkmcnt(0)
    s_mov_b32 s8, s18
    s_mov_b32 s9, s19
    s_mov_b32 s12, s20
    s_mov_b32 s13, s21
    s_lshr_b32 s7, s66, 3
    s_lshl_b32 s7, s7, 6
    s_and_b32 s42, s66, 7
    s_add_u32 s7, s7, s42
    s_add_u32 s7, s7, s43
    s_sub_u32 s42, s66, s49
    s_add_u32 s42, s42, 1920
    s_cmp_lt_u32 s66, s49
    s_cselect_b32 s42, s7, s42
    s_mov_b32 s66, s42
    s_mul_i32 s60, s66, 3072
    s_mov_b32 s62, 1
    s_cmp_lt_u32 s66, 2048
    s_cselect_b32 s63, s63, 1
    s_cselect_b32 s62, s62, 0x7fffffff
L_n_10:
L_m_11:
    s_waitcnt vmcnt(2)
    buffer_load_dwordx4 v[96:99], v1, s[8:11], s60 offen offset:0 nt
    buffer_load_dwordx4 v[100:103], v1, s[8:11], s60 offen offset:128 nt
    buffer_load_dwordx4 v[104:107], v1, s[8:11], s60 offen offset:256 nt
    buffer_load_dwordx4 v[108:111], v1, s[12:15], s60 offen offset:0 nt
    buffer_load_dwordx4 v[112:115], v1, s[12:15], s60 offen offset:128 nt
    buffer_load_dwordx4 v[116:119], v1, s[12:15], s60 offen offset:256 nt
    s_add_u32 s60, s60, s61
    s_sub_u32 s62, s62, 1
    ds_read_b64 v[46:47], v43
    v_add_u32 v43, 8, v43
    s_waitcnt vmcnt(6) lgkmcnt(0)
    v_and_b32 v32, v46, v36
    v_and_b32 v33, v46, v37
    v_and_b32 v34, v46, v38
    v_and_b32 v35, v46, v39
    v_and_b32 v16, v47, v36
    v_and_b32 v17, v47, v37
    v_mfma_f32_16x16x32_bf16 v[20:23], v[120:123], v[32:35], v[20:23]
    v_mfma_f32_16x16x32_bf16 v[24:27], v[124:127], v[32:35], v[24:27]
    v_mfma_f32_16x16x32_bf16 v[28:31], v[128:131], v[32:35], v[28:31]
    v_and_b32 v18, v47, v38
    v_and_b32 v19, v47, v39
    s_nop 1
    v_mfma_f32_16x16x32_bf16 v[20:23], v[132:135], v[16:19], v[20:23]
    v_mfma_f32_16x16x32_bf16 v[24:27], v[136:139], v[16:19], v[24:27]
    v_mfma_f32_16x16x32_bf16 v[28:31], v[140:143], v[16:19], v[28:31]
    s_cmp_lg_u32 s62, 0
    s_cbranch_scc1 L_n_12
    s_mov_b32 s66, 1
    s_atomic_add s66, s[64:65], 0x0 glc
    s_waitcnt vmcnt(2)
    s_waitcnt lgkmcnt(0)
    s_mov_b32 s8, s18
    s_mov_b32 s9, s19
    s_mov_b32 s12, s20
    s_mov_b32 s13, s21
    s_lshr_b32 s7, s66, 3
    s_lshl_b32 s7, s7, 6
    s_and_b32 s42, s66, 7
    s_add_u32 s7, s7, s42
    s_add_u32 s7, s7, s43
    s_sub_u32 s42, s66, s49
    s_add_u32 s42, s42, 1920
    s_cmp_lt_u32 s66, s49
    s_cselect_b32 s42, s7, s42
    s_mov_b32 s66, s42
    s_mul_i32 s60, s66, 3072
    s_mov_b32 s62, 1
    s_cmp_lt_u32 s66, 2048
    s_cselect_b32 s63, s63, 1
    s_cselect_b32 s62, s62, 0x7fffffff
L_n_12:
L_m_13:
    s_waitcnt vmcnt(2)
    buffer_load_dwordx4 v[120:123], v1, s[8:11], s60 offen offset:0 nt
    buffer_load_dwordx4 v[124:127], v1, s[8:11], s60 offen offset:128 nt
    buffer_load_dwordx4 v[128:131], v1, s[8:11], s60 offen offset:256 nt
    buffer_load_dwordx4 v[132:135], v1, s[12:15], s60 offen offset:0 nt
    buffer_load_dwordx4 v[136:139], v1, s[12:15], s60 offen offset:128 nt
    buffer_load_dwordx4 v[140:143], v1, s[12:15], s60 offen offset:256 nt
    s_add_u32 s60, s60, s61
    s_sub_u32 s62, s62, 1
    s_sub_u32 s55, s55, 2
    s_cmp_lg_u32 s55, 0
    s_cbranch_scc1 L_vloop
    s_sub_u32 s7, s62, 2147483645
    s_cmp_lt_u32 s63, 2
    s_cselect_b32 s63, s7, s63
    s_cmp_eq_u32 s63, 0
    s_cbranch_scc1 L_sdone
L_loop:
    s_waitcnt vmcnt(6)
    v_mov_b32 v16, 0
    v_dot2c_f32_bf16 v16, v96, v4
    v_dot2c_f32_bf16 v16, v97, v5
    v_dot2c_f32_bf16 v16, v98, v6
    v_dot2c_f32_bf16 v16, v99, v7
    v_dot2c_f32_bf16 v16, v100, v8
    v_dot2c_f32_bf16 v16, v101, v9
    v_dot2c_f32_bf16 v16, v102, v10
    v_dot2c_f32_bf16 v16, v103, v11
    v_dot2c_f32_bf16 v16, v104, v12
    v_dot2c_f32_bf16 v16, v105, v13
    v_dot2c_f32_bf16 v16, v106, v14
    v_dot2c_f32_bf16 v16, v107, v15
    s_nop 0
    s_nop 1
    v_add_f32_dpp v16, v16, v16 quad_perm:[1,0,3,2] row_mask:0xf bank_mask:0xf
    s_nop 1
    v_add_f32_dpp v16, v16, v16 quad_perm:[2,3,0,1] row_mask:0xf bank_mask:0xf
    s_nop 1
    v_add_f32_dpp v16, v16, v16 row_half_mirror row_mask:0xf bank_mask:0xf
    v_cvt_pk_bf16_f32 v17, v16, v16
    v_lshlrev_b32 v17, 16, v17
    v_mul_f32 v17, s67, v17
    v_cvt_pk_bf16_f32 v17, v17, v17
    v_lshlrev_b32 v17, 16, v17
    v_cmp_gt_f32 vcc, v17, v41
    s_cbranch_vccnz L_upd_14
L_back_15:
    v_sub_f32 v18, v17, v41
    v_mul_f32 v18, s68, v18
    v_exp_f32 v18, v18
    s_nop 0
    v_cvt_pk_bf16_f32 v19, v18, v18
    v_add_f32 v40, v40, v18
    v_and_b32 v32, v19, v36
    v_and_b32 v33, v19, v37
    v_and_b32 v34, v19, v38
    v_and_b32 v35, v19, v39
    s_nop 1
    v_mfma_f32_16x16x32_bf16 v[20:23], v[108:111], v[32:35], v[20:23]
    v_mfma_f32_16x16x32_bf16 v[24:27], v[112:115], v[32:35], v[24:27]
    v_mfma_f32_16x16x32_bf16 v[28:31], v[116:119], v[32:35], v[28:31]
    s_sub_u32 s63, s63, 1
    s_cmp_eq_u32 s63, 0
    s_cbranch_scc1 L_sdone
    s_cmp_lg_u32 s62, 0
    s_cbranch_scc1 L_n_16
    s_mov_b32 s66, 1
    s_atomic_add s66, s[64:65], 0x0 glc
    s_waitcnt vmcnt(4)
    s_waitcnt lgkmcnt(0)
    s_mov_b32 s8, s18
    s_mov_b32 s9, s19
    s_mov_b32 s12, s20
    s_mov_b32 s13, s21
    s_lshr_b32 s7, s66, 3
    s_lshl_b32 s7, s7, 6
    s_and_b32 s42, s66, 7
    s_add_u32 s7, s7, s42
    s_add_u32 s7, s7, s43
    s_sub_u32 s42, s66, s49
    s_add_u32 s42, s42, 1920
    s_cmp_lt_u32 s66, s49
    s_cselect_b32 s42, s7, s42
    s_mov_b32 s66, s42
    s_mul_i32 s60, s66, 3072
    s_mov_b32 s62, 1
    s_cmp_lt_u32 s66, 2048
    s_cselect_b32 s63, s63, 1
    s_cselect_b32 s62, s62, 0x7fffffff
L_n_16:
L_m_17:
    s_waitcnt vmcnt(4)
    buffer_load_dwordx4 v[96:99], v1, s[8:11], s60 offen offset:0 nt
    buffer_load_dwordx4 v[100:103], v1, s[8:11], s60 offen offset:128 nt
    buffer_load_dwordx4 v[104:107], v1, s[8:11], s60 offen offset:256 nt
    buffer_load_dwordx4 v[108:111], v1, s[12:15], s60 offen offset:0 nt
    buffer_load_dwordx4 v[112:115], v1, s[12:15], s60 offen offset:128 nt
    buffer_load_dwordx4 v[116:119], v1, s[12:15], s60 offen offset:256 nt
    s_add_u32 s60, s60, s61
    s_sub_u32 s62, s62, 1
    s_waitcnt vmcnt(6)
    v_mov_b32 v16, 0
    v_dot2c_f32_bf16 v16, v120, v4
    v_dot2c_f32_bf16 v16, v121, v5
    v_dot2c_f32_bf16 v16, v122, v6
    v_dot2c_f32_bf16 v16, v123, v7
    v_dot2c_f32_bf16 v16, v124, v8
    v_dot2c_f32_bf16 v16, v125, v9
    v_dot2c_f32_bf16 v16, v126, v10
    v_dot2c_f32_bf16 v16, v127, v11
    v_dot2c_f32_bf16 v16, v128, v12
    v_dot2c_f32_bf16 v16, v129, v13
    v_dot2c_f32_bf16 v16, v130, v14
    v_dot2c_f32_bf16 v16, v131, v15
    s_nop 0
    s_nop 1
    v_add_f32_dpp v16, v16, v16 quad_perm:[1,0,3,2] row_mask:0xf bank_mask:0xf
    s_nop 1
    v_add_f32_dpp v16, v16, v16 quad_perm:[2,3,0,1] row_mask:0xf bank_mask:0xf
    s_nop 1
    v_add_f32_dpp v16, v16, v16 row_half_mirror row_mask:0xf bank_mask:0xf
    v_cvt_pk_bf16_f32 v17, v16, v16
    v_lshlrev_b32 v17, 16, v17
    v_mul_f32 v17, s67, v17
    v_cvt_pk_bf16_f32 v17, v17, v17
    v_lshlrev_b32 v17, 16, v17
    v_cmp_gt_f32 vcc, v17, v41
    s_cbranch_vccnz L_upd_18
L_back_19:
    v_sub_f32 v18, v17, v41
    v_mul_f32 v18, s68, v18
    v_exp_f32 v18, v18
    s_nop 0
    v_cvt_pk_bf16_f32 v19, v18, v18
    v_add_f32 v40, v40, v18
    v_and_b32 v32, v19, v36
    v_and_b32 v33, v19, v37
    v_and_b32 v34, v19, v38
    v_and_b32 v35, v19, v39
    s_nop 1
    v_mfma_f32_16x16x32_bf16 v[20:23], v[132:135], v[32:35], v[20:23]
    v_mfma_f32_16x16x32_bf16 v[24:27], v[136:139], v[32:35], v[24:27]
    v_mfma_f32_16x16x32_bf16 v[28:31], v[140:143], v[32:35], v[28:31]
    s_sub_u32 s63, s63, 1
    s_cmp_eq_u32 s63, 0
    s_cbranch_scc1 L_sdone
    s_cmp_lg_u32 s62, 0
    s_cbranch_scc1 L_n_20
    s_mov_b32 s66, 1
    s_atomic_add s66, s[64:65], 0x0 glc
    s_waitcnt vmcnt(4)
    s_waitcnt lgkmcnt(0)
    s_mov_b32 s8, s18
    s_mov_b32 s9, s19
    s_mov_b32 s12, s20
    s_mov_b32 s13, s21
    s_lshr_b32 s7, s66, 3
    s_lshl_b32 s7, s7, 6
    s_and_b32 s42, s66, 7
    s_add_u32 s7, s7, s42
    s_add_u32 s7, s7, s43
    s_sub_u32 s42, s66, s49
    s_add_u32 s42, s42, 1920
    s_cmp_lt_u32 s66, s49
    s_cselect_b32 s42, s7, s42
    s_mov_b32 s66, s42
    s_mul_i32 s60, s66, 3072
    s_mov_b32 s62, 1
    s_cmp_lt_u32 s66, 2048
    s_cselect_b32 s63, s63, 1
    s_cselect_b32 s62, s62, 0x7fffffff
L_n_20:
L_m_21:
    s_waitcnt vmcnt(4)
    buffer_load_dwordx4 v[120:123], v1, s[8:11], s60 offen offset:0 nt
    buffer_load_dwordx4 v[124:127], v1, s[8:11], s60 offen offset:128 nt
    buffer_load_dwordx4 v[128:131], v1, s[8:11], s60 offen offset:256 nt
    buffer_load_dwordx4 v[132:135], v1, s[12:15], s60 offen offset:0 nt
    buffer_load_dwordx4 v[136:139], v1, s[12:15], s60 offen offset:128 nt
    buffer_load_dwordx4 v[140:143], v1, s[12:15], s60 offen offset:256 nt
    s_add_u32 s60, s60, s61
    s_sub_u32 s62, s62, 1
    s_branch L_loop
L_upd_14:
    v_mov_b32 v18, v17
    s_nop 1
    v_max_f32_dpp v18, v18, v18 row_ror:8 row_mask:0xf bank_mask:0xf
    s_nop 1
    v_max_f32_dpp v18, v18, v18 row_bcast:15 row_mask:0xa bank_mask:0xf
    s_nop 1
    v_max_f32_dpp v18, v18, v18 row_bcast:31 row_mask:0xc bank_mask:0xf
    s_nop 0
    v_readlane_b32 s7, v18, 63
    s_nop 1
    v_subrev_f32 v18, s7, v41
    v_mul_f32 v18, s68, v18
    v_exp_f32 v18, v18
    v_mov_b32 v41, s7
    v_mul_f32 v20, v20, v18
    v_mul_f32 v21, v21, v18
    v_mul_f32 v22, v22, v18
    v_mul_f32 v23, v23, v18
    v_mul_f32 v24, v24, v18
    v_mul_f32 v25, v25, v18
    v_mul_f32 v26, v26, v18
    v_mul_f32 v27, v27, v18
    v_mul_f32 v28, v28, v18
    v_mul_f32 v29, v29, v18
    v_mul_f32 v30, v30, v18
    v_mul_f32 v31, v31, v18
    v_mul_f32 v40, v40, v18
    s_branch L_back_15
L_upd_18:
    v_mov_b32 v18, v17
    s_nop 1
    v_max_f32_dpp v18, v18, v18 row_ror:8 row_mask:0xf bank_mask:0xf
    s_nop 1
    v_max_f32_dpp v18, v18, v18 row_bcast:15 row_mask:0xa bank_mask:0xf
    s_nop 1
    v_max_f32_dpp v18, v18, v18 row_bcast:31 row_mask:0xc bank_mask:0xf
    s_nop 0
    v_readlane_b32 s7, v18, 63
    s_nop 1
    v_subrev_f32 v18, s7, v41
    v_mul_f32 v18, s68, v18
    v_exp_f32 v18, v18
    v_mov_b32 v41, s7
    v_mul_f32 v20, v20, v18
    v_mul_f32 v21, v21, v18
    v_mul_f32 v22, v22, v18
    v_mul_f32 v23, v23, v18
    v_mul_f32 v24, v24, v18
    v_mul_f32 v25, v25, v18
    v_mul_f32 v26, v26, v18
    v_mul_f32 v27, v27, v18
    v_mul_f32 v28, v28, v18
    v_mul_f32 v29, v29, v18
    v_mul_f32 v30, v30, v18
    v_mul_f32 v31, v31, v18
    v_mul_f32 v40, v40, v18
    s_branch L_back_19
L_sdone:
    v_add_f32_dpp v40, v40, v40 row_ror:8 row_mask:0xf bank_mask:0xf
    v_mov_b32 v42, v41
    s_setprio 3
    v_add_f32_dpp v40, v40, v40 row_bcast:15 row_mask:0xa bank_mask:0xf
    s_mov_b32 exec_lo, 0x00ff00ff
    s_mov_b32 exec_hi, 0xff00ff00
    ds_write_b128 v2, v[20:23] offset:512
    s_mov_b64 exec, -1
    v_add_f32_dpp v43, v40, v40 row_bcast:31 row_mask:0xc bank_mask:0xf
    s_mov_b32 exec_lo, 0x00ff00ff
    s_mov_b32 exec_hi, 0xff00ff00
    ds_write_b128 v2, v[24:27] offset:768
    ds_write_b128 v2, v[28:31] offset:1024
    s_mov_b32 exec_lo, 0
    s_mov_b32 exec_hi, 0x80000000
    ds_write_b64 v253, v[42:43] offset:6656
    ds_add_rtn_u32 v18, v248, v254 offset:8648
    s_waitcnt lgkmcnt(0)
    v_readlane_b32 s7, v18, 63
    s_mov_b64 exec, -1
    s_cmp_lg_u32 s7, 3
    s_cbranch_scc1 L_not_last
    ds_read_b128 v[240:243], v248 offset:6656
    ds_read_b128 v[244:247], v248 offset:6672
    ds_read2_b32 v[208:209], v249 offset0:0 offset1:1
    ds_read2_b32 v[210:211], v249 offset0:2 offset1:194
    ds_read2_b32 v[212:213], v249 offset0:192 offset1:193
    ds_read2_b32 v[216:217], v250 offset0:0 offset1:1
    ds_read2_b32 v[218:219], v250 offset0:2 offset1:194
    ds_read2_b32 v[220:221], v250 offset0:192 offset1:193
    ds_read2_b32 v[224:225], v251 offset0:0 offset1:1
    ds_read2_b32 v[226:227], v251 offset0:2 offset1:194
    ds_read2_b32 v[228:229], v251 offset0:192 offset1:193
    ds_read2_b32 v[232:233], v252 offset0:0 offset1:1
    ds_read2_b32 v[234:235], v252 offset0:2 offset1:194
    ds_read2_b32 v[236:237], v252 offset0:192 offset1:193
    v_lshlrev_b32 v249, 4, v0
    v_mov_b32 v19, s6
    v_mov_b32 v18, 0
    s_waitcnt lgkmcnt(12)
    v_max3_f32 v16, v240, v242, v244
    v_max_f32 v16, v16, v246
    v_sub_f32 v240, v240, v16
    v_sub_f32 v242, v242, v16
    v_sub_f32 v244, v244, v16
    v_sub_f32 v246, v246, v16
    v_mul_f32 v240, s68, v240
    v_mul_f32 v242, s68, v242
    v_mul_f32 v244, s68, v244
    v_mul_f32 v246, s68, v246
    v_exp_f32 v240, v240
    v_exp_f32 v242, v242
    v_exp_f32 v244, v244
    v_exp_f32 v246, v246
    s_waitcnt lgkmcnt(0)
    v_add_f32 v208, v208, v212
    v_add_f32 v209, v209, v213
    v_add_f32 v210, v210, v211
    v_mul_f32 v208, v208, v240
    v_mul_f32 v209, v209, v240
    v_mul_f32 v210, v210, v240
    v_mov_b32 v211, s6
    v_add_f32 v216, v216, v220
    v_add_f32 v217, v217, v221
    v_add_f32 v218, v218, v219
    v_fmac_f32 v208, v216, v242
    v_fmac_f32 v209, v217, v242
    v_fmac_f32 v210, v218, v242
    v_add_f32 v224, v224, v228
    v_add_f32 v225, v225, v229
    v_add_f32 v226, v226, v227
    v_fmac_f32 v208, v224, v244
    v_fmac_f32 v209, v225, v244
    v_fmac_f32 v210, v226, v244
    v_add_f32 v232, v232, v236
    v_add_f32 v233, v233, v237
    v_add_f32 v234, v234, v235
    v_fmac_f32 v208, v232, v246
    v_fmac_f32 v209, v233, v246
    v_fmac_f32 v210, v234, v246
    buffer_store_dwordx4 v[208:211], v249, s[44:47], s94 offen sc1
    v_mul_f32 v17, v240, v241
    v_fmac_f32 v17, v242, v243
    v_fmac_f32 v17, v244, v245
    v_fmac_f32 v17, v246, v247
    s_mov_b64 exec, 1
    buffer_store_dwordx4 v[16:19], v248, s[44:47], s95 offen sc1
    s_mov_b64 exec, -1
    s_waitcnt vmcnt(0)
    s_mov_b64 exec, 1
    ds_add_u32 v248, v254 offset:8648
    s_mov_b64 exec, -1
L_not_last:
    s_cmp_eq_u32 s52, 2
    s_cbranch_scc1 L_t4
L_exit:
    s_endpgm
L_t4:
    v_and_b32 v252, 31, v0
    v_min_u32 v253, 29, v252
    s_mul_i32 s42, s69, 30
    v_add_u32 v253, s42, v253
    s_mov_b32 s42, 2731
    v_mul_u32_u24 v254, s42, v253
    v_lshrrev_b32 v254, 16, v254
    v_mul_u32_u24 v255, 24, v254
    v_sub_u32 v255, v253, v255
    v_cmp_gt_u32 s[54:55], 30, v0
    v_cmp_gt_u32 vcc, 22, v255
    v_min_u32 v255, 21, v255
    v_mul_u32_u24 v253, 24, v254
    v_add_u32 v253, v253, v255
    s_and_b64 s[54:55], vcc, s[54:55]
    v_lshrrev_b32 v251, 5, v0
    v_lshlrev_b32 v251, 15, v251
    v_lshl_add_u32 v251, v253, 4, v251
    v_cmp_gt_u32 vcc, 21, v255
    v_mul_u32_u24 v255, 3, v255
    v_lshl_add_u32 v248, v254, 6, v255
    v_lshlrev_b32 v248, 2, v248
    s_and_b64 s[58:59], vcc, s[54:55]
    v_add_u32 v249, 4, v248
    v_add_u32 v250, 8, v248
    v_cndmask_b32 v246, v248, v249, vcc
    v_cndmask_b32 v247, v248, v250, vcc
    v_mov_b32 v252, 2560
    v_cndmask_b32 v249, v252, v249, vcc
    v_cndmask_b32 v250, v252, v250, vcc
    s_cmp_lg_u32 s69, 0
    s_cbranch_scc1 L_zw_22
    s_cmp_ge_u32 s4, 16
    s_cbranch_scc1 L_zw_22
    v_lshrrev_b32 v8, 4, v0
    v_mul_u32_u24 v8, 24576, v8
    v_and_b32 v4, 15, v0
    v_lshl_add_u32 v8, v4, 4, v8
    s_lshl_b32 s42, s4, 8
    v_add_u32 v8, s42, v8
    s_waitcnt vmcnt(0)
    s_mov_b32 s56, 1114112
    buffer_load_dwordx4 v[48:51], v8, s[44:47], s56 offen sc1
    s_mov_b32 s56, 1118208
    buffer_load_dwordx4 v[52:55], v8, s[44:47], s56 offen sc1
    s_mov_b32 s56, 1122304
    buffer_load_dwordx4 v[56:59], v8, s[44:47], s56 offen sc1
    s_mov_b32 s56, 1126400
    buffer_load_dwordx4 v[60:63], v8, s[44:47], s56 offen sc1
    s_mov_b32 s56, 1130496
    buffer_load_dwordx4 v[64:67], v8, s[44:47], s56 offen sc1
    s_mov_b32 s56, 1134592
    buffer_load_dwordx4 v[68:71], v8, s[44:47], s56 offen sc1
L_zw_22:
    v_mov_b32 v253, 0
    s_mov_b32 s57, 320000
L_w_23:
    ds_read_b32 v254, v253 offset:8652
    s_sub_u32 s57, s57, 1
    s_waitcnt lgkmcnt(0)
    v_readfirstlane_b32 s7, v254
    s_cmp_eq_u32 s57, 0
    s_cbranch_scc1 L_wok_24
    s_cmp_ge_u32 s7, 4
    s_cbranch_scc1 L_wok_24
    s_sleep 1
    s_branch L_w_23
L_wok_24:
    ds_read_b32 v240, v248 offset:22528
    ds_read_b32 v243, v248 offset:12288
    ds_read_b32 v255, v248 offset:17408
    v_lshrrev_b32 v20, 1, v248
    ds_read_b32 v241, v246 offset:22528
    ds_read_b32 v244, v246 offset:12288
    ds_read_b32 v246, v246 offset:17408
    v_lshrrev_b32 v21, 1, v249
    ds_read_b32 v242, v247 offset:22528
    ds_read_b32 v245, v247 offset:12288
    ds_read_b32 v247, v247 offset:17408
    v_lshrrev_b32 v22, 1, v250
    s_lshl_b32 s42, s69, 3
    v_mov_b32 v252, s42
    s_waitcnt vmcnt(0)
    s_waitcnt lgkmcnt(0)
    s_mov_b32 s57, 320000
L_w_25:
    ds_read_b32 v254, v253 offset:8648
    s_sub_u32 s57, s57, 1
    s_waitcnt lgkmcnt(0)
    v_readfirstlane_b32 s7, v254
    s_cmp_eq_u32 s57, 0
    s_cbranch_scc1 L_wok_26
    s_cmp_ge_u32 s7, 5
    s_cbranch_scc1 L_wok_26
    s_sleep 1
    s_branch L_w_25
L_wok_26:
    s_mov_b32 s57, 40000
    s_mov_b32 s56, 851968
    buffer_load_dwordx4 v[208:211], v251, s[44:47], s56 offen sc1
    s_mov_b32 s56, 856064
    buffer_load_dwordx4 v[212:215], v251, s[44:47], s56 offen sc1
    s_mov_b32 s56, 860160
    buffer_load_dwordx4 v[216:219], v251, s[44:47], s56 offen sc1
    s_mov_b32 s56, 864256
    buffer_load_dwordx4 v[220:223], v251, s[44:47], s56 offen sc1
    s_mov_b32 s56, 868352
    buffer_load_dwordx4 v[224:227], v251, s[44:47], s56 offen sc1
    s_mov_b32 s56, 872448
    buffer_load_dwordx4 v[228:231], v251, s[44:47], s56 offen sc1
    s_mov_b32 s56, 876544
    buffer_load_dwordx4 v[232:235], v251, s[44:47], s56 offen sc1
    s_mov_b32 s56, 880640
    buffer_load_dwordx4 v[236:239], v251, s[44:47], s56 offen sc1
L_poll_27:
    s_waitcnt vmcnt(0)
    v_xor_b32 v253, s6, v211
    v_bitop3_b32 v253, v253, v215, s6 bitop3:0xf6
    v_bitop3_b32 v253, v253, v219, s6 bitop3:0xf6
    v_bitop3_b32 v253, v253, v223, s6 bitop3:0xf6
    v_bitop3_b32 v253, v253, v227, s6 bitop3:0xf6
    v_bitop3_b32 v253, v253, v231, s6 bitop3:0xf6
    v_bitop3_b32 v253, v253, v235, s6 bitop3:0xf6
    v_bitop3_b32 v253, v253, v239, s6 bitop3:0xf6
    v_cmp_ne_u32 vcc, 0, v253
    s_cbranch_vccz L_ok_28
    v_cmp_ne_u32 s[16:17], s6, v211
    v_cmp_ne_u32 s[18:19], s6, v215
    v_cmp_ne_u32 s[20:21], s6, v219
    v_cmp_ne_u32 s[22:23], s6, v223
    v_cmp_ne_u32 s[24:25], s6, v227
    v_cmp_ne_u32 s[26:27], s6, v231
    v_cmp_ne_u32 s[28:29], s6, v235
    v_cmp_ne_u32 s[30:31], s6, v239
    s_sub_u32 s57, s57, 1
    s_cmp_eq_u32 s57, 0
    s_cbranch_scc1 L_ok_28
    s_cmp_eq_u64 s[16:17], 0
    s_cbranch_scc1 L_sk_29
    s_mov_b32 s56, 851968
    buffer_load_dwordx4 v[208:211], v251, s[44:47], s56 offen sc1
L_sk_29:
    s_cmp_eq_u64 s[18:19], 0
    s_cbranch_scc1 L_sk_30
    s_mov_b32 s56, 856064
    buffer_load_dwordx4 v[212:215], v251, s[44:47], s56 offen sc1
L_sk_30:
    s_cmp_eq_u64 s[20:21], 0
    s_cbranch_scc1 L_sk_31
    s_mov_b32 s56, 860160
    buffer_load_dwordx4 v[216:219], v251, s[44:47], s56 offen sc1
L_sk_31:
    s_cmp_eq_u64 s[22:23], 0
    s_cbranch_scc1 L_sk_32
    s_mov_b32 s56, 864256
    buffer_load_dwordx4 v[220:223], v251, s[44:47], s56 offen sc1
L_sk_32:
    s_cmp_eq_u64 s[24:25], 0
    s_cbranch_scc1 L_sk_33
    s_mov_b32 s56, 868352
    buffer_load_dwordx4 v[224:227], v251, s[44:47], s56 offen sc1
L_sk_33:
    s_cmp_eq_u64 s[26:27], 0
    s_cbranch_scc1 L_sk_34
    s_mov_b32 s56, 872448
    buffer_load_dwordx4 v[228:231], v251, s[44:47], s56 offen sc1
L_sk_34:
    s_cmp_eq_u64 s[28:29], 0
    s_cbranch_scc1 L_sk_35
    s_mov_b32 s56, 876544
    buffer_load_dwordx4 v[232:235], v251, s[44:47], s56 offen sc1
L_sk_35:
    s_cmp_eq_u64 s[30:31], 0
    s_cbranch_scc1 L_sk_36
    s_mov_b32 s56, 880640
    buffer_load_dwordx4 v[236:239], v251, s[44:47], s56 offen sc1
L_sk_36:
    s_branch L_poll_27
L_ok_28:
    v_add_f32 v208, v208, v212
    v_add_f32 v209, v209, v213
    v_add_f32 v210, v210, v214
    v_add_f32 v216, v216, v220
    v_add_f32 v217, v217, v221
    v_add_f32 v218, v218, v222
    v_add_f32 v224, v224, v228
    v_add_f32 v225, v225, v229
    v_add_f32 v226, v226, v230
    v_add_f32 v232, v232, v236
    v_add_f32 v233, v233, v237
    v_add_f32 v234, v234, v238
    v_add_f32 v208, v208, v216
    v_add_f32 v209, v209, v217
    v_add_f32 v210, v210, v218
    v_add_f32 v224, v224, v232
    v_add_f32 v225, v225, v233
    v_add_f32 v226, v226, v234
    v_add_f32 v208, v208, v224
    v_add_f32 v209, v209, v225
    v_add_f32 v210, v210, v226
    v_mov_b32 v212, v208
    v_mov_b32 v213, v209
    v_mov_b32 v214, v210
    s_nop 0
    v_permlane32_swap_b32 v208, v212
    v_permlane32_swap_b32 v209, v213
    v_permlane32_swap_b32 v210, v214
    v_add_f32 v208, v208, v212
    v_add_f32 v209, v209, v213
    v_add_f32 v210, v210, v214
    s_waitcnt lgkmcnt(0)
    v_cvt_pk_bf16_f32 v208, v208, v208
    v_cvt_pk_bf16_f32 v209, v209, v209
    v_cvt_pk_bf16_f32 v210, v210, v210
    v_lshlrev_b32 v208, 16, v208
    v_lshlrev_b32 v209, 16, v209
    v_lshlrev_b32 v210, 16, v210
    v_mul_f32 v208, v208, v243
    v_mul_f32 v209, v209, v244
    v_mul_f32 v210, v210, v245
    v_cvt_pk_bf16_f32 v208, v208, v208
    v_cvt_pk_bf16_f32 v209, v209, v209
    v_cvt_pk_bf16_f32 v210, v210, v210
    v_lshlrev_b32 v208, 16, v208
    v_lshlrev_b32 v209, 16, v209
    v_lshlrev_b32 v210, 16, v210
    v_add_f32 v208, v208, v240
    v_add_f32 v209, v209, v241
    v_add_f32 v210, v210, v242
    v_cvt_pk_bf16_f32 v208, v208, v208
    v_cvt_pk_bf16_f32 v209, v209, v209
    v_cvt_pk_bf16_f32 v210, v210, v210
    v_lshlrev_b32 v208, 16, v208
    v_lshlrev_b32 v209, 16, v209
    v_lshlrev_b32 v210, 16, v210
    v_cndmask_b32 v212, 0, v208, s[54:55]
    v_cndmask_b32 v213, 0, v209, s[58:59]
    v_cndmask_b32 v214, 0, v210, s[58:59]
    v_add_f32 v216, v212, v213
    v_mul_f32 v217, v212, v212
    v_add_f32 v216, v216, v214
    v_fmac_f32 v217, v213, v213
    v_fmac_f32 v217, v214, v214
    v_mul_f32 v255, v255, v208
    v_mul_f32 v246, v246, v209
    v_mul_f32 v247, v247, v210
    v_cvt_pk_bf16_f32 v220, v255, v255
    v_cvt_pk_bf16_f32 v221, v246, v246
    v_cvt_pk_bf16_f32 v222, v247, v247
    v_add_f32_dpp v216, v216, v216 quad_perm:[1,0,3,2] row_mask:0xf bank_mask:0xf
    v_add_f32_dpp v217, v217, v217 quad_perm:[1,0,3,2] row_mask:0xf bank_mask:0xf
    ds_write_b16 v20, v220 offset:27904
    v_lshlrev_b32 v224, 16, v220
    ds_write_b16 v21, v221 offset:27904
    v_lshlrev_b32 v225, 16, v221
    ds_write_b16 v22, v222 offset:27904
    v_add_f32_dpp v216, v216, v216 quad_perm:[2,3,0,1] row_mask:0xf bank_mask:0xf
    v_add_f32_dpp v217, v217, v217 quad_perm:[2,3,0,1] row_mask:0xf bank_mask:0xf
    v_lshlrev_b32 v226, 16, v222
    v_sub_f32 v255, v255, v224
    v_sub_f32 v246, v246, v225
    v_sub_f32 v247, v247, v226
    v_cvt_pk_bf16_f32 v255, v255, v255
    v_add_f32_dpp v216, v216, v216 row_half_mirror row_mask:0xf bank_mask:0xf
    v_add_f32_dpp v217, v217, v217 row_half_mirror row_mask:0xf bank_mask:0xf
    ds_write_b16 v20, v255 offset:29248
    v_cvt_pk_bf16_f32 v246, v246, v246
    ds_write_b16 v21, v246 offset:29248
    v_cvt_pk_bf16_f32 v247, v247, v247
    v_add_f32_dpp v216, v216, v216 row_mirror row_mask:0xf bank_mask:0xf
    v_add_f32_dpp v217, v217, v217 row_mirror row_mask:0xf bank_mask:0xf
    ds_write_b16 v22, v247 offset:29248
    ds_write_b32 v248, v208 offset:25088
    ds_write_b32 v249, v209 offset:25088
    ds_write_b32 v250, v210 offset:25088
    v_add_f32_dpp v216, v216, v216 row_bcast:15 row_mask:0xa bank_mask:0xf
    v_add_f32_dpp v217, v217, v217 row_bcast:15 row_mask:0xa bank_mask:0xf
    s_nop 0
    v_add_f32_dpp v216, v216, v216 row_bcast:31 row_mask:0xc bank_mask:0xf
    v_add_f32_dpp v217, v217, v217 row_bcast:31 row_mask:0xc bank_mask:0xf
    s_mov_b32 exec_lo, 0
    s_mov_b32 exec_hi, 0x80000000
    ds_write_b64 v252, v[216:217] offset:27776
    s_mov_b64 exec, -1
    s_waitcnt lgkmcnt(0)
    s_barrier
    s_cmp_ge_u32 s69, 4
    s_cbranch_scc1 L_t5b
    s_cmp_lg_u32 s69, 0
    s_cbranch_scc1 L_exit
    s_cmp_ge_u32 s4, 16
    s_cbranch_scc1 L_exit
    v_and_b32 v4, 15, v0
    s_lshr_b32 s42, s4, 2
    s_mul_i32 s42, s42, 160
    s_and_b32 s43, s4, 3
    s_mul_i32 s56, s43, 48
    s_add_u32 s42, s42, s56
    v_lshrrev_b32 v8, 4, v0
    v_min_u32 v5, 2, v8
    s_cmp_eq_u32 s43, 3
    s_cselect_b32 s56, 0, 16
    v_mul_u32_u24 v5, s56, v5
    v_add3_u32 v5, v5, v4, s42
    v_lshlrev_b32 v7, 2, v5
    v_lshlrev_b32 v6, 1, v5
    ds_read_b32 v9, v7 offset:25088
    ds_read_b32 v10, v7 offset:19968
    v_cmp_eq_u32 s[94:95], 1, v8
    v_cmp_le_u32 s[96:97], 2, v8
    s_cselect_b32 s98, 0, -1
    v_mul_u32_u24 v8, 24576, v8
    v_lshl_add_u32 v8, v4, 4, v8
    s_lshl_b32 s42, s4, 8
    v_add_u32 v8, s42, v8
    s_and_b32 s94, s94, s98
    s_and_b32 s96, s96, s98
    s_and_b32 s97, s97, s98
    s_mov_b32 s8, s36
    s_mov_b32 s9, s37
    s_mov_b32 s10, 1280
    s_mov_b32 s11, 0x20000
    s_barrier
    s_mov_b32 s42, 983040
    s_mov_b32 s62, 1114112
    s_mov_b32 s57, 40000
    s_cmp_lt_u32 s57, 39995
    s_cselect_b32 s43, s57, 0
    s_bitcmp1_b32 s43, 0
    s_cselect_b32 s43, s42, s62
    s_add_u32 s56, s43, 0
    buffer_load_dwordx4 v[48:51], v8, s[44:47], s56 offen sc1
    s_add_u32 s56, s43, 4096
    buffer_load_dwordx4 v[52:55], v8, s[44:47], s56 offen sc1
    s_add_u32 s56, s43, 8192
    buffer_load_dwordx4 v[56:59], v8, s[44:47], s56 offen sc1
    s_add_u32 s56, s43, 12288
    buffer_load_dwordx4 v[60:63], v8, s[44:47], s56 offen sc1
    s_add_u32 s56, s43, 16384
    buffer_load_dwordx4 v[64:67], v8, s[44:47], s56 offen sc1
    s_add_u32 s56, s43, 20480
    buffer_load_dwordx4 v[68:71], v8, s[44:47], s56 offen sc1
L_poll_37:
    s_waitcnt vmcnt(0)
    v_xor_b32 v4, s6, v51
    v_bitop3_b32 v4, v4, v55, s6 bitop3:0xf6
    v_bitop3_b32 v4, v4, v59, s6 bitop3:0xf6
    v_bitop3_b32 v4, v4, v63, s6 bitop3:0xf6
    v_bitop3_b32 v4, v4, v67, s6 bitop3:0xf6
    v_bitop3_b32 v4, v4, v71, s6 bitop3:0xf6
    v_cmp_ne_u32 vcc, 0, v4
    s_cbranch_vccz L_ok_38
    v_cmp_ne_u32 s[16:17], s6, v51
    v_cmp_ne_u32 s[18:19], s6, v55
    v_cmp_ne_u32 s[20:21], s6, v59
    v_cmp_ne_u32 s[22:23], s6, v63
    v_cmp_ne_u32 s[24:25], s6, v67
    v_cmp_ne_u32 s[26:27], s6, v71
    s_sub_u32 s57, s57, 1
    s_cmp_eq_u32 s57, 0
    s_cbranch_scc1 L_ok_38
    s_cmp_lt_u32 s57, 39995
    s_cselect_b32 s43, s57, 0
    s_bitcmp1_b32 s43, 0
    s_cselect_b32 s43, s42, s62
    s_cmp_eq_u64 s[16:17], 0
    s_cbranch_scc1 L_sk_39
    s_add_u32 s56, s43, 0
    buffer_load_dwordx4 v[48:51], v8, s[44:47], s56 offen sc1
L_sk_39:
    s_cmp_eq_u64 s[18:19], 0
    s_cbranch_scc1 L_sk_40
    s_add_u32 s56, s43, 4096
    buffer_load_dwordx4 v[52:55], v8, s[44:47], s56 offen sc1
L_sk_40:
    s_cmp_eq_u64 s[20:21], 0
    s_cbranch_scc1 L_sk_41
    s_add_u32 s56, s43, 8192
    buffer_load_dwordx4 v[56:59], v8, s[44:47], s56 offen sc1
L_sk_41:
    s_cmp_eq_u64 s[22:23], 0
    s_cbranch_scc1 L_sk_42
    s_add_u32 s56, s43, 12288
    buffer_load_dwordx4 v[60:63], v8, s[44:47], s56 offen sc1
L_sk_42:
    s_cmp_eq_u64 s[24:25], 0
    s_cbranch_scc1 L_sk_43
    s_add_u32 s56, s43, 16384
    buffer_load_dwordx4 v[64:67], v8, s[44:47], s56 offen sc1
L_sk_43:
    s_cmp_eq_u64 s[26:27], 0
    s_cbranch_scc1 L_sk_44
    s_add_u32 s56, s43, 20480
    buffer_load_dwordx4 v[68:71], v8, s[44:47], s56 offen sc1
L_sk_44:
    s_branch L_poll_37
L_ok_38:
    v_add_f32 v48, v48, v52
    v_add_f32 v49, v49, v53
    v_add_f32 v50, v50, v54
    v_add_f32 v56, v56, v60
    v_add_f32 v57, v57, v61
    v_add_f32 v58, v58, v62
    v_add_f32 v64, v64, v68
    v_add_f32 v65, v65, v69
    v_add_f32 v66, v66, v70
    v_add_f32 v48, v48, v56
    v_add_f32 v49, v49, v57
    v_add_f32 v50, v50, v58
    v_add_f32 v48, v48, v64
    v_add_f32 v49, v49, v65
    v_add_f32 v50, v50, v66
    v_mov_b32 v12, v48
    v_mov_b32 v13, v49
    v_mov_b32 v14, v50
    s_nop 0
    v_permlane32_swap_b32 v12, v48
    v_permlane32_swap_b32 v13, v49
    v_permlane32_swap_b32 v14, v50
    v_add_f32 v48, v12, v48
    v_add_f32 v49, v13, v49
    v_add_f32 v50, v14, v50
    v_mov_b32 v12, v48
    v_mov_b32 v13, v49
    v_mov_b32 v14, v50
    s_nop 0
    v_permlane16_swap_b32 v12, v48
    v_permlane16_swap_b32 v13, v49
    v_permlane16_swap_b32 v14, v50
    v_add_f32 v48, v12, v48
    v_add_f32 v49, v13, v49
    v_add_f32 v50, v14, v50
    v_cndmask_b32 v11, v48, v49, s[94:95]
    v_cndmask_b32 v11, v11, v50, s[96:97]
    s_waitcnt lgkmcnt(0)
    v_cvt_pk_bf16_f32 v11, v11, v11
    v_lshlrev_b32 v11, 16, v11
    v_mul_f32 v11, v11, v10
    v_cvt_pk_bf16_f32 v11, v11, v11
    v_lshlrev_b32 v11, 16, v11
    v_add_f32 v11, v11, v9
    v_cvt_pk_bf16_f32 v11, v11, v11
    buffer_store_short v11, v6, s[8:11], 0 offen
    s_cmp_lg_u32 s4, 0
    s_cbranch_scc1 L_exit
    s_mov_b64 exec, 1
    v_mov_b32 v4, 0
    v_mov_b32 v5, s6
    buffer_store_dword v5, v4, s[44:47], 0 offen
    s_branch L_exit
L_t5b:
    ds_read_b128 v[20:23], v18 offset:27776
    ds_read_b128 v[24:27], v18 offset:27792
    ds_read_b128 v[28:31], v18 offset:27808
    ds_read_b128 v[32:35], v18 offset:27824
    ds_read_b128 v[208:211], v12 offset:27904
    ds_read_b128 v[212:215], v12 offset:27968
    ds_read_b128 v[216:219], v12 offset:28032
    ds_read_b128 v[220:223], v12 offset:28096
    ds_read_b128 v[224:227], v12 offset:28160
    ds_read_b128 v[228:231], v12 offset:28224
    ds_read_b128 v[232:235], v12 offset:28288
    ds_read_b128 v[236:239], v12 offset:28352
    ds_read_b128 v[240:243], v12 offset:28416
    ds_read_b128 v[244:247], v12 offset:28480
    s_waitcnt lgkmcnt(9)
    v_mfma_f32_16x16x32_bf16 v[36:39], v[208:211], v[48:51], 0
    ds_read_b128 v[208:211], v12 offset:28544
    v_add_f32 v20, v20, v22
    v_add_f32 v21, v21, v23
    s_waitcnt lgkmcnt(9)
    v_mfma_f32_16x16x32_bf16 v[36:39], v[212:215], v[52:55], v[36:39]
    ds_read_b128 v[212:215], v12 offset:28608
    v_add_f32 v24, v24, v26
    v_add_f32 v25, v25, v27
    s_waitcnt lgkmcnt(9)
    v_mfma_f32_16x16x32_bf16 v[36:39], v[216:219], v[56:59], v[36:39]
    ds_read_b128 v[216:219], v12 offset:28672
    v_add_f32 v28, v28, v30
    v_add_f32 v29, v29, v31
    s_waitcnt lgkmcnt(9)
    v_mfma_f32_16x16x32_bf16 v[36:39], v[220:223], v[60:63], v[36:39]
    ds_read_b128 v[220:223], v12 offset:28736
    v_add_f32 v32, v32, v34
    v_add_f32 v33, v33, v35
    s_waitcnt lgkmcnt(9)
    v_mfma_f32_16x16x32_bf16 v[36:39], v[224:227], v[64:67], v[36:39]
    ds_read_b128 v[224:227], v12 offset:28800
    v_add_f32 v20, v20, v24
    v_add_f32 v21, v21, v25
    s_waitcnt lgkmcnt(9)
    v_mfma_f32_16x16x32_bf16 v[36:39], v[228:231], v[68:71], v[36:39]
    ds_read_b128 v[228:231], v12 offset:28864
    v_add_f32 v28, v28, v32
    v_add_f32 v29, v29, v33
    s_waitcnt lgkmcnt(9)
    v_mfma_f32_16x16x32_bf16 v[36:39], v[232:235], v[72:75], v[36:39]
    ds_read_b128 v[232:235], v12 offset:28928
    v_add_f32 v20, v20, v28
    v_add_f32 v21, v21, v29
    s_waitcnt lgkmcnt(9)
    v_mfma_f32_16x16x32_bf16 v[36:39], v[236:239], v[76:79], v[36:39]
    ds_read_b128 v[236:239], v12 offset:28992
    v_mul_f32 v20, 0x3acccccd, v20
    v_mul_f32 v21, 0x3acccccd, v21
    s_waitcnt lgkmcnt(9)
    v_mfma_f32_16x16x32_bf16 v[36:39], v[240:243], v[80:83], v[36:39]
    ds_read_b128 v[240:243], v12 offset:29056
    v_fma_f32 v21, -v20, v20, v21
    v_max_f32 v21, 0, v21
    s_waitcnt lgkmcnt(9)
    v_mfma_f32_16x16x32_bf16 v[36:39], v[244:247], v[84:87], v[36:39]
    ds_read_b128 v[244:247], v12 offset:29120
    v_cvt_pk_bf16_f32 v20, v20, v20
    v_cvt_pk_bf16_f32 v21, v21, v21
    s_waitcnt lgkmcnt(9)
    v_mfma_f32_16x16x32_bf16 v[36:39], v[208:211], v[88:91], v[36:39]
    v_lshlrev_b32 v20, 16, v20
    v_lshlrev_b32 v21, 16, v21
    s_waitcnt lgkmcnt(8)
    v_mfma_f32_16x16x32_bf16 v[36:39], v[212:215], v[92:95], v[36:39]
    v_add_f32 v21, 0x3727c5ac, v21
    s_waitcnt lgkmcnt(7)
    v_mfma_f32_16x16x32_bf16 v[36:39], v[216:219], v[96:99], v[36:39]
    v_cvt_pk_bf16_f32 v21, v21, v21
    s_waitcnt lgkmcnt(6)
    v_mfma_f32_16x16x32_bf16 v[36:39], v[220:223], v[100:103], v[36:39]
    v_lshlrev_b32 v21, 16, v21
    s_waitcnt lgkmcnt(5)
    v_mfma_f32_16x16x32_bf16 v[36:39], v[224:227], v[104:107], v[36:39]
    v_sqrt_f32 v21, v21
    s_waitcnt lgkmcnt(4)
    v_mfma_f32_16x16x32_bf16 v[36:39], v[228:231], v[108:111], v[36:39]
    v_mul_f32 v20, v20, v4
    s_waitcnt lgkmcnt(3)
    v_mfma_f32_16x16x32_bf16 v[36:39], v[232:235], v[112:115], v[36:39]
    v_cvt_pk_bf16_f32 v21, v21, v21
    s_waitcnt lgkmcnt(2)
    v_mfma_f32_16x16x32_bf16 v[36:39], v[236:239], v[116:119], v[36:39]
    v_lshlrev_b32 v21, 16, v21
    s_waitcnt lgkmcnt(1)
    v_mfma_f32_16x16x32_bf16 v[36:39], v[240:243], v[120:123], v[36:39]
    v_rcp_f32 v21, v21
    s_waitcnt lgkmcnt(0)
    v_mfma_f32_16x16x32_bf16 v[36:39], v[244:247], v[124:127], v[36:39]
    s_nop 7
    v_add_f32 v36, v36, v37
    v_sub_f32 v36, v36, v20
    v_fma_f32 v36, v36, v21, v5
    v_cvt_pk_bf16_f32 v36, v36, v36
    v_lshlrev_b32 v36, 16, v36
    v_mul_f32 v37, 0xbfb8aa3b, v36
    v_exp_f32 v37, v37
    s_nop 0
    v_add_f32 v37, 1.0, v37
    v_rcp_f32 v37, v37
    s_nop 0
    v_mul_f32 v36, v36, v37
    v_cvt_pk_bf16_f32 v36, v36, v36
    ds_write_b16 v15, v36
    s_waitcnt lgkmcnt(0)
    s_barrier
    ds_read_b128 v[228:231], v16 offset:0
    ds_read_b128 v[232:235], v16 offset:64
    s_waitcnt lgkmcnt(1)
    v_mfma_f32_16x16x32_bf16 v[48:51], v[228:231], v[128:131], 0
    v_mfma_f32_16x16x32_bf16 v[52:55], v[228:231], v[132:135], 0
    v_mfma_f32_16x16x32_bf16 v[56:59], v[228:231], v[136:139], 0
    v_mfma_f32_16x16x32_bf16 v[60:63], v[228:231], v[140:143], 0
    v_mfma_f32_16x16x32_bf16 v[64:67], v[228:231], v[144:147], 0
    v_mfma_f32_16x16x32_bf16 v[68:71], v[228:231], v[148:151], 0
    v_mfma_f32_16x16x32_bf16 v[72:75], v[228:231], v[152:155], 0
    v_mfma_f32_16x16x32_bf16 v[76:79], v[228:231], v[156:159], 0
    v_mfma_f32_16x16x32_bf16 v[80:83], v[228:231], v[160:163], 0
    v_mfma_f32_16x16x32_bf16 v[84:87], v[228:231], v[164:167], 0
    s_waitcnt lgkmcnt(0)
    v_mfma_f32_16x16x32_bf16 v[48:51], v[232:235], v[168:171], v[48:51]
    v_mfma_f32_16x16x32_bf16 v[52:55], v[232:235], v[172:175], v[52:55]
    v_mfma_f32_16x16x32_bf16 v[56:59], v[232:235], v[176:179], v[56:59]
    v_mfma_f32_16x16x32_bf16 v[60:63], v[232:235], v[180:183], v[60:63]
    v_mfma_f32_16x16x32_bf16 v[64:67], v[232:235], v[184:187], v[64:67]
    v_mfma_f32_16x16x32_bf16 v[68:71], v[232:235], v[188:191], v[68:71]
    v_mfma_f32_16x16x32_bf16 v[72:75], v[232:235], v[192:195], v[72:75]
    v_mfma_f32_16x16x32_bf16 v[76:79], v[232:235], v[196:199], v[76:79]
    v_mfma_f32_16x16x32_bf16 v[80:83], v[232:235], v[200:203], v[80:83]
    v_mfma_f32_16x16x32_bf16 v[84:87], v[232:235], v[204:207], v[84:87]
    v_mov_b32 v23, s6
    s_nop 0
    v_cndmask_b32 v20, v48, v60, s[94:95]
    v_cndmask_b32 v21, v52, v64, s[94:95]
    v_cndmask_b32 v22, v56, v68, s[94:95]
    v_cndmask_b32 v20, v20, v72, s[96:97]
    v_cndmask_b32 v21, v21, v76, s[96:97]
    v_cndmask_b32 v22, v22, v80, s[96:97]
    v_cndmask_b32 v20, v20, v84, s[98:99]
    buffer_store_dwordx4 v[20:23], v17, s[44:47], s61 offen
    buffer_store_dwordx4 v[20:23], v17, s[44:47], s60 offen sc1
    s_branch L_exit
L_service:
    s_setprio 3
    s_sub_u32 s3, s3, 4
    s_waitcnt lgkmcnt(0)
    s_load_dword s6, s[40:41], 0
    s_mov_b32 s44, s40
    s_mov_b32 s45, s41
    s_mov_b32 s46, 805306368
    s_mov_b32 s47, 0x20000
    s_cmp_eq_u32 s3, 1
    s_cbranch_scc1 L_s1
    s_cmp_eq_u32 s3, 2
    s_cbranch_scc1 L_s2
    s_cmp_lg_u32 s3, 0
    s_cbranch_scc1 L_s0_skip
    s_and_b32 s42, s5, 3
    s_lshl_b32 s43, s4, 2
    s_add_u32 s42, s42, s43
    s_add_u32 s43, s42, 128
    s_cmp_lt_u32 s5, 4
    s_cselect_b32 s43, s42, s43
    s_cmp_ge_u32 s43, 240
    s_cbranch_scc1 L_s0_skip
    s_sub_u32 s56, s43, 80
    s_mul_i32 s57, s56, 1639
    s_lshr_b32 s57, s57, 16
    s_mul_i32 s58, s57, 40
    s_sub_u32 s56, s56, s58
    s_add_u32 s56, s56, 20
    s_mul_i32 s42, s43, 3277
    s_lshr_b32 s42, s42, 16
    s_mul_i32 s58, s42, 20
    s_sub_u32 s58, s43, s58
    s_cmp_lt_u32 s43, 80
    s_cselect_b32 s42, s42, s57
    s_cselect_b32 s43, s58, s56
    s_mov_b32 s8, s32
    s_mov_b32 s9, s33
    s_mov_b32 s10, 1280
    s_mov_b32 s11, 0x20000
    s_mov_b32 s12, s34
    s_mov_b32 s13, s35
    s_mov_b32 s14, 4915200
    s_mov_b32 s15, 0x20000
    v_mul_u32_u24 v4, 20, v1
    v_add_u32 v5, v4, v2
    v_lshlrev_b32 v6, 1, v5
    s_mul_i32 s56, s42, 320
    buffer_load_ushort v8, v6, s[8:11], s56 offen
    buffer_load_ushort v9, v6, s[8:11], s56 offen offset:16
    buffer_load_ushort v10, v6, s[8:11], s56 offen offset:32
    v_mul_u32_u24 v7, 7680, v4
    v_add_u32 v7, v7, v3
    s_mul_i32 s56, s42, 1228800
    s_lshl_b32 s57, s43, 7
    s_add_u32 s56, s56, s57
    buffer_load_dwordx4 v[48:51], v7, s[12:15], s56 offen nt
    s_add_u32 s56, s56, 7680
    buffer_load_dwordx4 v[52:55], v7, s[12:15], s56 offen nt
    s_add_u32 s56, s56, 7680
    buffer_load_dwordx4 v[56:59], v7, s[12:15], s56 offen nt
    s_add_u32 s56, s56, 7680
    buffer_load_dwordx4 v[60:63], v7, s[12:15], s56 offen nt
    s_add_u32 s56, s56, 7680
    buffer_load_dwordx4 v[64:67], v7, s[12:15], s56 offen nt
    s_add_u32 s56, s56, 7680
    buffer_load_dwordx4 v[68:71], v7, s[12:15], s56 offen nt
    s_add_u32 s56, s56, 7680
    buffer_load_dwordx4 v[72:75], v7, s[12:15], s56 offen nt
    s_add_u32 s56, s56, 7680
    buffer_load_dwordx4 v[76:79], v7, s[12:15], s56 offen nt
    s_add_u32 s56, s56, 7680
    buffer_load_dwordx4 v[80:83], v7, s[12:15], s56 offen nt
    s_add_u32 s56, s56, 7680
    buffer_load_dwordx4 v[84:87], v7, s[12:15], s56 offen nt
    s_add_u32 s56, s56, 7680
    buffer_load_dwordx4 v[88:91], v7, s[12:15], s56 offen nt
    s_add_u32 s56, s56, 7680
    buffer_load_dwordx4 v[92:95], v7, s[12:15], s56 offen nt
    s_add_u32 s56, s56, 7680
    buffer_load_dwordx4 v[96:99], v7, s[12:15], s56 offen nt
    s_add_u32 s56, s56, 7680
    buffer_load_dwordx4 v[100:103], v7, s[12:15], s56 offen nt
    s_add_u32 s56, s56, 7680
    buffer_load_dwordx4 v[104:107], v7, s[12:15], s56 offen nt
    s_add_u32 s56, s56, 7680
    buffer_load_dwordx4 v[108:111], v7, s[12:15], s56 offen nt
    s_add_u32 s56, s56, 7680
    buffer_load_dwordx4 v[112:115], v7, s[12:15], s56 offen nt
    s_add_u32 s56, s56, 7680
    buffer_load_dwordx4 v[116:119], v7, s[12:15], s56 offen nt
    s_add_u32 s56, s56, 7680
    buffer_load_dwordx4 v[120:123], v7, s[12:15], s56 offen nt
    s_add_u32 s56, s56, 7680
    buffer_load_dwordx4 v[124:127], v7, s[12:15], s56 offen nt
    s_barrier
    v_and_b32 v36, 1, v0
    v_lshlrev_b32 v36, 4, v36
    v_mov_b32 v37, 0xffff
    v_lshlrev_b32 v39, v36, v37
    v_bfe_u32 v38, v0, 1, 2
    v_cmp_eq_u32 vcc, 0, v38
    v_cmp_eq_u32 s[58:59], 1, v38
    s_nop 1
    v_cndmask_b32 v36, 0, v39, vcc
    v_cndmask_b32 v37, 0, v39, s[58:59]
    v_cmp_eq_u32 vcc, 2, v38
    v_cmp_eq_u32 s[58:59], 3, v38
    s_nop 1
    v_cndmask_b32 v38, 0, v39, vcc
    v_cndmask_b32 v39, 0, v39, s[58:59]
    v_lshlrev_b32 v6, 2, v5
    s_waitcnt vmcnt(20) lgkmcnt(0)
    s_mul_i32 s6, s6, 0x9e3779b1
    s_add_u32 s6, s6, 0x7f4a7c15
    v_lshlrev_b32 v8, 16, v8
    v_mul_f32 v11, 0xbfb8aa3b, v8
    v_exp_f32 v11, v11
    s_nop 0
    v_add_f32 v11, 1.0, v11
    v_rcp_f32 v11, v11
    s_nop 0
    v_mul_f32 v8, v8, v11
    v_cvt_pk_bf16_f32 v8, v8, v8
    v_lshlrev_b32 v9, 16, v9
    v_mul_f32 v11, 0xbfb8aa3b, v9
    v_exp_f32 v11, v11
    s_nop 0
    v_add_f32 v11, 1.0, v11
    v_rcp_f32 v11, v11
    s_nop 0
    v_mul_f32 v9, v9, v11
    v_cvt_pk_bf16_f32 v9, v9, v9
    v_lshlrev_b32 v10, 16, v10
    v_mul_f32 v11, 0xbfb8aa3b, v10
    v_exp_f32 v11, v11
    s_nop 0
    v_add_f32 v11, 1.0, v11
    v_rcp_f32 v11, v11
    s_nop 0
    v_mul_f32 v10, v10, v11
    v_cvt_pk_bf16_f32 v10, v10, v10
    ds_write_b32 v6, v8 offset:6912
    ds_write_b32 v6, v9 offset:6944
    s_mov_b32 exec_lo, 0x0f0f0f0f
    s_mov_b32 exec_hi, 0x0f0f0f0f
    ds_write_b32 v6, v10 offset:6976
    s_mov_b64 exec, -1
    v_lshlrev_b32 v6, 2, v4
    ds_read_b128 v[8:11], v6 offset:6912
    ds_read_b128 v[12:15], v6 offset:6928
    ds_read_b128 v[16:19], v6 offset:6944
    ds_read_b128 v[20:23], v6 offset:6960
    ds_read_b128 v[24:27], v6 offset:6976
    v_bfe_u32 v5, v0, 4, 1
    v_lshlrev_b32 v5, 3, v5
    v_and_b32 v4, 7, v0
    v_add_u32 v4, v4, v5
    v_lshlrev_b32 v4, 4, v4
    v_lshrrev_b32 v5, 5, v0
    v_lshl_add_u32 v4, v5, 8, v4
    v_min_u32 v6, 21, v0
    v_mul_u32_u24 v7, 3, v6
    v_lshlrev_b32 v6, 4, v6
    v_min_u32 v5, 63, v7
    v_and_b32 v47, 7, v5
    v_lshlrev_b32 v47, 2, v47
    v_and_b32 v44, 0xffffffe0, v5
    v_or_b32 v44, v44, v47
    v_bfe_u32 v47, v5, 3, 2
    v_or_b32 v44, v44, v47
    v_lshlrev_b32 v44, 2, v44
    v_add_u32 v7, 1, v7
    v_min_u32 v5, 63, v7
    v_and_b32 v47, 7, v5
    v_lshlrev_b32 v47, 2, v47
    v_and_b32 v45, 0xffffffe0, v5
    v_or_b32 v45, v45, v47
    v_bfe_u32 v47, v5, 3, 2
    v_or_b32 v45, v45, v47
    v_lshlrev_b32 v45, 2, v45
    v_add_u32 v7, 1, v7
    v_min_u32 v5, 63, v7
    v_and_b32 v47, 7, v5
    v_lshlrev_b32 v47, 2, v47
    v_and_b32 v46, 0xffffffe0, v5
    v_or_b32 v46, v46, v47
    v_bfe_u32 v47, v5, 3, 2
    v_or_b32 v46, v46, v47
    v_lshlrev_b32 v46, 2, v46
    s_mul_i32 s56, s42, 60
    s_add_u32 s56, s56, s43
    s_mul_i32 s56, s56, 384
    s_add_u32 s56, s56, 16384
    s_waitcnt lgkmcnt(0)
    v_and_b32 v32, v8, v36
    v_and_b32 v33, v8, v37
    v_and_b32 v34, v8, v38
    v_and_b32 v35, v8, v39
    s_waitcnt vmcnt(19)
    s_nop 0
    v_mfma_f32_16x16x32_bf16 v[28:31], v[48:51], v[32:35], 0
    v_and_b32 v40, v9, v36
    v_and_b32 v41, v9, v37
    v_and_b32 v42, v9, v38
    v_and_b32 v43, v9, v39
    s_waitcnt vmcnt(18)
    s_nop 0
    v_mfma_f32_16x16x32_bf16 v[28:31], v[52:55], v[40:43], v[28:31]
    v_and_b32 v32, v10, v36
    v_and_b32 v33, v10, v37
    v_and_b32 v34, v10, v38
    v_and_b32 v35, v10, v39
    s_waitcnt vmcnt(17)
    s_nop 0
    v_mfma_f32_16x16x32_bf16 v[28:31], v[56:59], v[32:35], v[28:31]
    v_and_b32 v40, v11, v36
    v_and_b32 v41, v11, v37
    v_and_b32 v42, v11, v38
    v_and_b32 v43, v11, v39
    s_waitcnt vmcnt(16)
    s_nop 0
    v_mfma_f32_16x16x32_bf16 v[28:31], v[60:63], v[40:43], v[28:31]
    v_and_b32 v32, v12, v36
    v_and_b32 v33, v12, v37
    v_and_b32 v34, v12, v38
    v_and_b32 v35, v12, v39
    s_waitcnt vmcnt(15)
    s_nop 0
    v_mfma_f32_16x16x32_bf16 v[28:31], v[64:67], v[32:35], v[28:31]
    v_and_b32 v40, v13, v36
    v_and_b32 v41, v13, v37
    v_and_b32 v42, v13, v38
    v_and_b32 v43, v13, v39
    s_waitcnt vmcnt(14)
    s_nop 0
    v_mfma_f32_16x16x32_bf16 v[28:31], v[68:71], v[40:43], v[28:31]
    v_and_b32 v32, v14, v36
    v_and_b32 v33, v14, v37
    v_and_b32 v34, v14, v38
    v_and_b32 v35, v14, v39
    s_waitcnt vmcnt(13)
    s_nop 0
    v_mfma_f32_16x16x32_bf16 v[28:31], v[72:75], v[32:35], v[28:31]
    v_and_b32 v40, v15, v36
    v_and_b32 v41, v15, v37
    v_and_b32 v42, v15, v38
    v_and_b32 v43, v15, v39
    s_waitcnt vmcnt(12)
    s_nop 0
    v_mfma_f32_16x16x32_bf16 v[28:31], v[76:79], v[40:43], v[28:31]
    v_and_b32 v32, v16, v36
    v_and_b32 v33, v16, v37
    v_and_b32 v34, v16, v38
    v_and_b32 v35, v16, v39
    s_waitcnt vmcnt(11)
    s_nop 0
    v_mfma_f32_16x16x32_bf16 v[28:31], v[80:83], v[32:35], v[28:31]
    v_and_b32 v40, v17, v36
    v_and_b32 v41, v17, v37
    v_and_b32 v42, v17, v38
    v_and_b32 v43, v17, v39
    s_waitcnt vmcnt(10)
    s_nop 0
    v_mfma_f32_16x16x32_bf16 v[28:31], v[84:87], v[40:43], v[28:31]
    v_and_b32 v32, v18, v36
    v_and_b32 v33, v18, v37
    v_and_b32 v34, v18, v38
    v_and_b32 v35, v18, v39
    s_waitcnt vmcnt(9)
    s_nop 0
    v_mfma_f32_16x16x32_bf16 v[28:31], v[88:91], v[32:35], v[28:31]
    v_and_b32 v40, v19, v36
    v_and_b32 v41, v19, v37
    v_and_b32 v42, v19, v38
    v_and_b32 v43, v19, v39
    s_waitcnt vmcnt(8)
    s_nop 0
    v_mfma_f32_16x16x32_bf16 v[28:31], v[92:95], v[40:43], v[28:31]
    v_and_b32 v32, v20, v36
    v_and_b32 v33, v20, v37
    v_and_b32 v34, v20, v38
    v_and_b32 v35, v20, v39
    s_waitcnt vmcnt(7)
    s_nop 0
    v_mfma_f32_16x16x32_bf16 v[28:31], v[96:99], v[32:35], v[28:31]
    v_and_b32 v40, v21, v36
    v_and_b32 v41, v21, v37
    v_and_b32 v42, v21, v38
    v_and_b32 v43, v21, v39
    s_waitcnt vmcnt(6)
    s_nop 0
    v_mfma_f32_16x16x32_bf16 v[28:31], v[100:103], v[40:43], v[28:31]
    v_and_b32 v32, v22, v36
    v_and_b32 v33, v22, v37
    v_and_b32 v34, v22, v38
    v_and_b32 v35, v22, v39
    s_waitcnt vmcnt(5)
    s_nop 0
    v_mfma_f32_16x16x32_bf16 v[28:31], v[104:107], v[32:35], v[28:31]
    v_and_b32 v40, v23, v36
    v_and_b32 v41, v23, v37
    v_and_b32 v42, v23, v38
    v_and_b32 v43, v23, v39
    s_waitcnt vmcnt(4)
    s_nop 0
    v_mfma_f32_16x16x32_bf16 v[28:31], v[108:111], v[40:43], v[28:31]
    v_and_b32 v32, v24, v36
    v_and_b32 v33, v24, v37
    v_and_b32 v34, v24, v38
    v_and_b32 v35, v24, v39
    s_waitcnt vmcnt(3)
    s_nop 0
    v_mfma_f32_16x16x32_bf16 v[28:31], v[112:115], v[32:35], v[28:31]
    v_and_b32 v40, v25, v36
    v_and_b32 v41, v25, v37
    v_and_b32 v42, v25, v38
    v_and_b32 v43, v25, v39
    s_waitcnt vmcnt(2)
    s_nop 0
    v_mfma_f32_16x16x32_bf16 v[28:31], v[116:119], v[40:43], v[28:31]
    v_and_b32 v32, v26, v36
    v_and_b32 v33, v26, v37
    v_and_b32 v34, v26, v38
    v_and_b32 v35, v26, v39
    s_waitcnt vmcnt(1)
    s_nop 0
    v_mfma_f32_16x16x32_bf16 v[28:31], v[120:123], v[32:35], v[28:31]
    v_and_b32 v40, v27, v36
    v_and_b32 v41, v27, v37
    v_and_b32 v42, v27, v38
    v_and_b32 v43, v27, v39
    s_waitcnt vmcnt(0)
    s_nop 0
    v_mfma_f32_16x16x32_bf16 v[28:31], v[124:127], v[40:43], v[28:31]
    s_nop 5
    s_mov_b32 exec_lo, 0x00ff00ff
    s_mov_b32 exec_hi, 0xff00ff00
    ds_write_b128 v4, v[28:31] offset:7552
    s_mov_b64 exec, -1
    ds_read_b32 v8, v44 offset:7552
    ds_read_b32 v12, v44 offset:7808
    ds_read_b32 v9, v45 offset:7552
    ds_read_b32 v13, v45 offset:7808
    ds_read_b32 v10, v46 offset:7552
    ds_read_b32 v14, v46 offset:7808
    v_mov_b32 v11, s6
    s_mov_b32 exec_lo, 0x3fffff
    s_mov_b32 exec_hi, 0
    s_waitcnt lgkmcnt(0)
    v_add_f32 v8, v8, v12
    v_add_f32 v9, v9, v13
    v_add_f32 v10, v10, v14
    buffer_store_dwordx4 v[8:11], v6, s[44:47], s56 offen sc1
    s_mov_b64 exec, -1
    s_branch L_pro_done
L_s0_skip:
    s_barrier
    s_waitcnt lgkmcnt(0)
    s_mul_i32 s6, s6, 0x9e3779b1
    s_add_u32 s6, s6, 0x7f4a7c15
    s_branch L_pro_done
L_s1:
    s_mov_b32 s8, s16
    s_mov_b32 s9, s17
    s_mov_b32 s10, 1280
    s_mov_b32 s11, 0x20000
    v_lshlrev_b32 v4, 2, v0
    buffer_load_dword v10, v4, s[8:11], 0 offen offset:0
    buffer_load_dword v11, v4, s[8:11], 0 offen offset:256
    buffer_load_dword v12, v4, s[8:11], 0 offen offset:512
    buffer_load_dword v13, v4, s[8:11], 0 offen offset:768
    buffer_load_dword v14, v4, s[8:11], 0 offen offset:1024
    s_mul_i32 s42, s5, 80
    s_lshr_b32 s43, s42, 6
    s_mul_i32 s43, s43, 22
    s_and_b32 s56, s42, 63
    s_mul_i32 s56, s56, 86
    s_lshr_b32 s56, s56, 8
    s_add_u32 s43, s43, s56
    v_and_b32 v5, 31, v0
    v_add_u32 v5, s43, v5
    v_min_u32 v5, 219, v5
    s_mov_b32 s43, 2979
    v_mul_u32_u24 v6, s43, v5
    v_lshrrev_b32 v6, 16, v6
    v_mul_u32_u24 v7, 22, v6
    v_sub_u32 v7, v5, v7
    v_mul_u32_u24 v8, 3, v7
    v_lshl_add_u32 v9, v6, 6, v8
    v_add_u32 v15, 0, v9
    v_min_u32 v15, 639, v15
    v_lshlrev_b32 v15, 1, v15
    buffer_load_ushort v15, v15, s[8:11], 0 offen
    v_add_u32 v16, 1, v9
    v_min_u32 v16, 639, v16
    v_lshlrev_b32 v16, 1, v16
    buffer_load_ushort v16, v16, s[8:11], 0 offen
    v_add_u32 v17, 2, v9
    v_min_u32 v17, 639, v17
    v_lshlrev_b32 v17, 1, v17
    buffer_load_ushort v17, v17, s[8:11], 0 offen
    s_barrier
    v_mul_u32_u24 v5, 384, v6
    v_lshl_add_u32 v5, v7, 4, v5
    v_lshrrev_b32 v6, 5, v0
    v_mul_u32_u24 v6, 3840, v6
    v_add_u32 v5, v5, v6
    v_mov_b32 v7, 400
    s_mov_b32 s60, 80
    v_add_u32 v6, 0, v8
    v_cmp_gt_u32 vcc, 64, v6
    v_add_u32 v6, 0, v9
    v_subrev_u32 v6, s42, v6
    v_cmp_gt_u32 s[58:59], s60, v6
    v_lshlrev_b32 v6, 2, v6
    s_and_b64 vcc, vcc, s[58:59]
    v_cndmask_b32 v32, v7, v6, vcc
    v_add_u32 v6, 1, v8
    v_cmp_gt_u32 vcc, 64, v6
    v_add_u32 v6, 1, v9
    v_subrev_u32 v6, s42, v6
    v_cmp_gt_u32 s[58:59], s60, v6
    v_lshlrev_b32 v6, 2, v6
    s_and_b64 vcc, vcc, s[58:59]
    v_cndmask_b32 v33, v7, v6, vcc
    v_add_u32 v6, 2, v8
    v_cmp_gt_u32 vcc, 64, v6
    v_add_u32 v6, 2, v9
    v_subrev_u32 v6, s42, v6
    v_cmp_gt_u32 s[58:59], s60, v6
    v_lshlrev_b32 v6, 2, v6
    s_and_b64 vcc, vcc, s[58:59]
    v_cndmask_b32 v34, v7, v6, vcc
    s_waitcnt vmcnt(3) lgkmcnt(0)
    s_mul_i32 s6, s6, 0x9e3779b1
    s_add_u32 s6, s6, 0x7f4a7c15
    v_lshlrev_b32 v18, 16, v10
    v_and_b32 v19, 0xffff0000, v10
    v_lshlrev_b32 v20, 16, v11
    v_and_b32 v21, 0xffff0000, v11
    v_lshlrev_b32 v22, 16, v12
    v_and_b32 v23, 0xffff0000, v12
    v_lshlrev_b32 v24, 16, v13
    v_and_b32 v25, 0xffff0000, v13
    v_lshlrev_b32 v26, 16, v14
    v_and_b32 v27, 0xffff0000, v14
    v_add_f32 v30, v18, v19
    v_add_f32 v30, v30, v20
    v_add_f32 v30, v30, v21
    v_add_f32 v30, v30, v22
    v_add_f32 v30, v30, v23
    v_add_f32 v30, v30, v24
    v_add_f32 v30, v30, v25
    v_add_f32 v30, v30, v26
    v_add_f32 v30, v30, v27
    s_nop 1
    v_add_f32_dpp v30, v30, v30 quad_perm:[1,0,3,2] row_mask:0xf bank_mask:0xf
    s_nop 1
    v_add_f32_dpp v30, v30, v30 quad_perm:[2,3,0,1] row_mask:0xf bank_mask:0xf
    s_nop 1
    v_add_f32_dpp v30, v30, v30 row_half_mirror row_mask:0xf bank_mask:0xf
    s_nop 1
    v_add_f32_dpp v30, v30, v30 row_mirror row_mask:0xf bank_mask:0xf
    s_nop 1
    v_add_f32_dpp v30, v30, v30 row_bcast:15 row_mask:0xa bank_mask:0xf
    s_nop 1
    v_add_f32_dpp v30, v30, v30 row_bcast:31 row_mask:0xc bank_mask:0xf
    s_nop 0
    v_readlane_b32 s7, v30, 63
    s_nop 1
    v_mov_b32 v28, 0x3acccccd
    v_mul_f32 v28, s7, v28
    v_mov_b32 v30, 0
    v_sub_f32 v31, v18, v28
    v_fmac_f32 v30, v31, v31
    v_sub_f32 v31, v19, v28
    v_fmac_f32 v30, v31, v31
    v_sub_f32 v31, v20, v28
    v_fmac_f32 v30, v31, v31
    v_sub_f32 v31, v21, v28
    v_fmac_f32 v30, v31, v31
    v_sub_f32 v31, v22, v28
    v_fmac_f32 v30, v31, v31
    v_sub_f32 v31, v23, v28
    v_fmac_f32 v30, v31, v31
    v_sub_f32 v31, v24, v28
    v_fmac_f32 v30, v31, v31
    v_sub_f32 v31, v25, v28
    v_fmac_f32 v30, v31, v31
    v_sub_f32 v31, v26, v28
    v_fmac_f32 v30, v31, v31
    v_sub_f32 v31, v27, v28
    v_fmac_f32 v30, v31, v31
    s_nop 1
    v_add_f32_dpp v30, v30, v30 quad_perm:[1,0,3,2] row_mask:0xf bank_mask:0xf
    s_nop 1
    v_add_f32_dpp v30, v30, v30 quad_perm:[2,3,0,1] row_mask:0xf bank_mask:0xf
    s_nop 1
    v_add_f32_dpp v30, v30, v30 row_half_mirror row_mask:0xf bank_mask:0xf
    s_nop 1
    v_add_f32_dpp v30, v30, v30 row_mirror row_mask:0xf bank_mask:0xf
    s_nop 1
    v_add_f32_dpp v30, v30, v30 row_bcast:15 row_mask:0xa bank_mask:0xf
    s_nop 1
    v_add_f32_dpp v30, v30, v30 row_bcast:31 row_mask:0xc bank_mask:0xf
    s_nop 0
    v_readlane_b32 s7, v30, 63
    s_nop 1
    v_mov_b32 v29, 0x3acccccd
    v_mul_f32 v29, s7, v29
    v_cvt_pk_bf16_f32 v29, v29, v29
    v_lshlrev_b32 v29, 16, v29
    v_add_f32 v29, 0x3727c5ac, v29
    v_cvt_pk_bf16_f32 v29, v29, v29
    v_lshlrev_b32 v29, 16, v29
    v_sqrt_f32 v29, v29
    s_nop 0
    v_cvt_pk_bf16_f32 v29, v29, v29
    v_lshlrev_b32 v29, 16, v29
    v_rcp_f32 v29, v29
    v_cvt_pk_bf16_f32 v28, v28, v28
    v_lshlrev_b32 v28, 16, v28
    s_waitcnt vmcnt(0)
    v_lshlrev_b32 v15, 16, v15
    v_sub_f32 v15, v15, v28
    v_cvt_pk_bf16_f32 v15, v15, v15
    v_lshlrev_b32 v15, 16, v15
    v_mul_f32 v15, v15, v29
    v_cvt_pk_bf16_f32 v15, v15, v15
    v_lshlrev_b32 v15, 16, v15
    v_lshlrev_b32 v16, 16, v16
    v_sub_f32 v16, v16, v28
    v_cvt_pk_bf16_f32 v16, v16, v16
    v_lshlrev_b32 v16, 16, v16
    v_mul_f32 v16, v16, v29
    v_cvt_pk_bf16_f32 v16, v16, v16
    v_lshlrev_b32 v16, 16, v16
    v_lshlrev_b32 v17, 16, v17
    v_sub_f32 v17, v17, v28
    v_cvt_pk_bf16_f32 v17, v17, v17
    v_lshlrev_b32 v17, 16, v17
    v_mul_f32 v17, v17, v29
    v_cvt_pk_bf16_f32 v17, v17, v17
    v_lshlrev_b32 v17, 16, v17
    v_mul_u32_u24 v12, 3, v0
    v_lshlrev_b32 v6, 4, v0
    v_and_b32 v13, 3, v12
    v_lshlrev_b32 v13, 3, v13
    v_and_b32 v9, 0xffffffe0, v12
    v_or_b32 v9, v9, v13
    v_bfe_u32 v13, v12, 2, 3
    v_or_b32 v9, v9, v13
    v_lshlrev_b32 v9, 1, v9
    v_add_u32 v12, 1, v12
    v_and_b32 v13, 3, v12
    v_lshlrev_b32 v13, 3, v13
    v_and_b32 v10, 0xffffffe0, v12
    v_or_b32 v10, v10, v13
    v_bfe_u32 v13, v12, 2, 3
    v_or_b32 v10, v10, v13
    v_lshlrev_b32 v10, 1, v10
    v_add_u32 v12, 1, v12
    v_and_b32 v13, 3, v12
    v_lshlrev_b32 v13, 3, v13
    v_and_b32 v11, 0xffffffe0, v12
    v_or_b32 v11, v11, v13
    v_bfe_u32 v13, v12, 2, 3
    v_or_b32 v11, v11, v13
    v_lshlrev_b32 v11, 1, v11
    v_mov_b32 v4, 0
    s_mov_b32 s57, 320000
L_w_45:
    ds_read_b32 v14, v4 offset:8664
    s_sub_u32 s57, s57, 1
    s_waitcnt lgkmcnt(0)
    v_readfirstlane_b32 s7, v14
    s_cmp_eq_u32 s57, 0
    s_cbranch_scc1 L_wok_46
    s_cmp_ge_u32 s7, 1
    s_cbranch_scc1 L_wok_46
    s_sleep 2
    s_branch L_w_45
L_wok_46:
    s_mov_b32 s57, 40000
    s_mov_b32 s7, -1
L_poll_47:
    s_bitcmp0_b32 s7, 0
    s_cbranch_scc1 L_sk_49
    s_mov_b32 s56, 16384
    buffer_load_dwordx4 v[48:51], v5, s[44:47], s56 offen sc1
L_sk_49:
    s_bitcmp0_b32 s7, 1
    s_cbranch_scc1 L_sk_50
    s_mov_b32 s56, 39424
    buffer_load_dwordx4 v[52:55], v5, s[44:47], s56 offen sc1
L_sk_50:
    s_bitcmp0_b32 s7, 2
    s_cbranch_scc1 L_sk_51
    s_mov_b32 s56, 62464
    buffer_load_dwordx4 v[56:59], v5, s[44:47], s56 offen sc1
L_sk_51:
    s_bitcmp0_b32 s7, 3
    s_cbranch_scc1 L_sk_52
    s_mov_b32 s56, 85504
    buffer_load_dwordx4 v[60:63], v5, s[44:47], s56 offen sc1
L_sk_52:
    s_sub_u32 s57, s57, 1
    s_waitcnt vmcnt(0)
    v_xor_b32 v14, s6, v51
    v_bitop3_b32 v14, v14, v55, s6 bitop3:0xf6
    v_bitop3_b32 v14, v14, v59, s6 bitop3:0xf6
    v_bitop3_b32 v14, v14, v63, s6 bitop3:0xf6
    v_cmp_ne_u32 vcc, 0, v14
    s_cbranch_vccz L_ok_48
    s_cmp_eq_u32 s57, 0
    s_cbranch_scc1 L_ok_48
    s_mov_b32 s7, 0
    v_cmp_ne_u32 vcc, s6, v51
    s_nop 0
    s_cmp_lg_u64 vcc, 0
    s_cselect_b32 s56, 1, 0
    s_or_b32 s7, s7, s56
    v_cmp_ne_u32 vcc, s6, v55
    s_nop 0
    s_cmp_lg_u64 vcc, 0
    s_cselect_b32 s56, 2, 0
    s_or_b32 s7, s7, s56
    v_cmp_ne_u32 vcc, s6, v59
    s_nop 0
    s_cmp_lg_u64 vcc, 0
    s_cselect_b32 s56, 4, 0
    s_or_b32 s7, s7, s56
    v_cmp_ne_u32 vcc, s6, v63
    s_nop 0
    s_cmp_lg_u64 vcc, 0
    s_cselect_b32 s56, 8, 0
    s_or_b32 s7, s7, s56
    s_sleep 1
    s_branch L_poll_47
L_ok_48:
    v_add_f32 v48, v48, v52
    v_add_f32 v49, v49, v53
    v_add_f32 v50, v50, v54
    v_add_f32 v56, v56, v60
    v_add_f32 v57, v57, v61
    v_add_f32 v58, v58, v62
    v_add_f32 v48, v48, v56
    v_add_f32 v49, v49, v57
    v_add_f32 v50, v50, v58
    v_cvt_pk_bf16_f32 v48, v48, v48
    v_lshlrev_b32 v48, 16, v48
    v_cvt_pk_bf16_f32 v49, v49, v49
    v_lshlrev_b32 v49, 16, v49
    v_cvt_pk_bf16_f32 v50, v50, v50
    v_lshlrev_b32 v50, 16, v50
    v_mov_b32 v52, v48
    v_mov_b32 v53, v49
    v_mov_b32 v54, v50
    s_nop 0
    v_permlane32_swap_b32 v48, v52
    v_permlane32_swap_b32 v49, v53
    v_permlane32_swap_b32 v50, v54
    v_add_f32 v52, 1.0, v52
    v_cvt_pk_bf16_f32 v52, v52, v52
    v_lshlrev_b32 v52, 16, v52
    v_mul_f32 v15, v15, v52
    v_cvt_pk_bf16_f32 v15, v15, v15
    v_lshlrev_b32 v15, 16, v15
    v_add_f32 v15, v15, v48
    v_cvt_pk_bf16_f32 v15, v15, v15
    ds_write_b32 v32, v15 offset:8192
    v_add_f32 v53, 1.0, v53
    v_cvt_pk_bf16_f32 v53, v53, v53
    v_lshlrev_b32 v53, 16, v53
    v_mul_f32 v16, v16, v53
    v_cvt_pk_bf16_f32 v16, v16, v16
    v_lshlrev_b32 v16, 16, v16
    v_add_f32 v16, v16, v49
    v_cvt_pk_bf16_f32 v16, v16, v16
    ds_write_b32 v33, v16 offset:8192
    v_add_f32 v54, 1.0, v54
    v_cvt_pk_bf16_f32 v54, v54, v54
    v_lshlrev_b32 v54, 16, v54
    v_mul_f32 v17, v17, v54
    v_cvt_pk_bf16_f32 v17, v17, v17
    v_lshlrev_b32 v17, 16, v17
    v_add_f32 v17, v17, v50
    v_cvt_pk_bf16_f32 v17, v17, v17
    ds_write_b32 v34, v17 offset:8192
    v_mov_b32 v4, 0
    v_mov_b32 v7, 1
    ds_write_b32 v4, v7 offset:8640
    s_lshl_b32 s42, s4, 13
    s_add_u32 s42, s42, 196608
    s_add_u32 s43, s42, 4096
    s_mov_b32 s57, 320000
L_w_53:
    ds_read_b32 v14, v4 offset:8640
    s_sub_u32 s57, s57, 1
    s_waitcnt lgkmcnt(0)
    v_readfirstlane_b32 s7, v14
    s_cmp_eq_u32 s57, 0
    s_cbranch_scc1 L_wok_54
    s_cmp_ge_u32 s7, 2
    s_cbranch_scc1 L_wok_54
    s_sleep 1
    s_branch L_w_53
L_wok_54:
    s_mov_b32 s57, 40000
    s_mov_b32 s7, -1
L_poll_55:
    s_bitcmp0_b32 s7, 0
    s_cbranch_scc1 L_sk_57
    buffer_load_dwordx4 v[48:51], v6, s[44:47], s42 offen offset:0 sc1
L_sk_57:
    s_bitcmp0_b32 s7, 1
    s_cbranch_scc1 L_sk_58
    buffer_load_dwordx4 v[52:55], v6, s[44:47], s42 offen offset:1024 sc1
L_sk_58:
    s_bitcmp0_b32 s7, 2
    s_cbranch_scc1 L_sk_59
    buffer_load_dwordx4 v[56:59], v6, s[44:47], s42 offen offset:2048 sc1
L_sk_59:
    s_bitcmp0_b32 s7, 3
    s_cbranch_scc1 L_sk_60
    buffer_load_dwordx4 v[60:63], v6, s[44:47], s42 offen offset:3072 sc1
L_sk_60:
    s_bitcmp0_b32 s7, 4
    s_cbranch_scc1 L_sk_61
    buffer_load_dwordx4 v[64:67], v6, s[44:47], s43 offen offset:0 sc1
L_sk_61:
    s_bitcmp0_b32 s7, 5
    s_cbranch_scc1 L_sk_62
    buffer_load_dwordx4 v[68:71], v6, s[44:47], s43 offen offset:1024 sc1
L_sk_62:
    s_bitcmp0_b32 s7, 6
    s_cbranch_scc1 L_sk_63
    buffer_load_dwordx4 v[72:75], v6, s[44:47], s43 offen offset:2048 sc1
L_sk_63:
    s_bitcmp0_b32 s7, 7
    s_cbranch_scc1 L_sk_64
    buffer_load_dwordx4 v[76:79], v6, s[44:47], s43 offen offset:3072 sc1
L_sk_64:
    s_sub_u32 s57, s57, 1
    s_waitcnt vmcnt(0)
    v_xor_b32 v14, s6, v51
    v_bitop3_b32 v14, v14, v55, s6 bitop3:0xf6
    v_bitop3_b32 v14, v14, v59, s6 bitop3:0xf6
    v_bitop3_b32 v14, v14, v63, s6 bitop3:0xf6
    v_bitop3_b32 v14, v14, v67, s6 bitop3:0xf6
    v_bitop3_b32 v14, v14, v71, s6 bitop3:0xf6
    v_bitop3_b32 v14, v14, v75, s6 bitop3:0xf6
    v_bitop3_b32 v14, v14, v79, s6 bitop3:0xf6
    v_cmp_ne_u32 vcc, 0, v14
    s_cbranch_vccz L_ok_56
    s_cmp_eq_u32 s57, 0
    s_cbranch_scc1 L_ok_56
    s_mov_b32 s7, 0
    v_cmp_ne_u32 vcc, s6, v51
    s_nop 0
    s_cmp_lg_u64 vcc, 0
    s_cselect_b32 s56, 1, 0
    s_or_b32 s7, s7, s56
    v_cmp_ne_u32 vcc, s6, v55
    s_nop 0
    s_cmp_lg_u64 vcc, 0
    s_cselect_b32 s56, 2, 0
    s_or_b32 s7, s7, s56
    v_cmp_ne_u32 vcc, s6, v59
    s_nop 0
    s_cmp_lg_u64 vcc, 0
    s_cselect_b32 s56, 4, 0
    s_or_b32 s7, s7, s56
    v_cmp_ne_u32 vcc, s6, v63
    s_nop 0
    s_cmp_lg_u64 vcc, 0
    s_cselect_b32 s56, 8, 0
    s_or_b32 s7, s7, s56
    v_cmp_ne_u32 vcc, s6, v67
    s_nop 0
    s_cmp_lg_u64 vcc, 0
    s_cselect_b32 s56, 16, 0
    s_or_b32 s7, s7, s56
    v_cmp_ne_u32 vcc, s6, v71
    s_nop 0
    s_cmp_lg_u64 vcc, 0
    s_cselect_b32 s56, 32, 0
    s_or_b32 s7, s7, s56
    v_cmp_ne_u32 vcc, s6, v75
    s_nop 0
    s_cmp_lg_u64 vcc, 0
    s_cselect_b32 s56, 64, 0
    s_or_b32 s7, s7, s56
    v_cmp_ne_u32 vcc, s6, v79
    s_nop 0
    s_cmp_lg_u64 vcc, 0
    s_cselect_b32 s56, 128, 0
    s_or_b32 s7, s7, s56
    s_sleep 1
    s_branch L_poll_55
L_ok_56:
    v_add_f32 v48, v48, v52
    v_add_f32 v49, v49, v53
    v_add_f32 v50, v50, v54
    v_add_f32 v56, v56, v60
    v_add_f32 v57, v57, v61
    v_add_f32 v58, v58, v62
    v_add_f32 v64, v64, v68
    v_add_f32 v65, v65, v69
    v_add_f32 v66, v66, v70
    v_add_f32 v72, v72, v76
    v_add_f32 v73, v73, v77
    v_add_f32 v74, v74, v78
    v_add_f32 v48, v48, v56
    v_add_f32 v49, v49, v57
    v_add_f32 v50, v50, v58
    v_add_f32 v64, v64, v72
    v_add_f32 v65, v65, v73
    v_add_f32 v66, v66, v74
    v_add_f32 v48, v48, v64
    v_add_f32 v49, v49, v65
    v_add_f32 v50, v50, v66
    v_cvt_pk_bf16_f32 v48, v48, v48
    ds_write_b16 v9, v48 offset:0
    v_cvt_pk_bf16_f32 v49, v49, v49
    ds_write_b16 v10, v49 offset:0
    v_cvt_pk_bf16_f32 v50, v50, v50
    ds_write_b16 v11, v50 offset:0
    ds_write_b32 v4, v7 offset:8644
    s_waitcnt vmcnt(0) lgkmcnt(0)
    s_branch L_pro_done
L_s2:
    s_mov_b32 s12, s22
    s_mov_b32 s13, s23
    s_mov_b32 s14, 7864320
    s_mov_b32 s15, 0x20000
    v_mov_b32 v4, 0
    v_mov_b32 v5, 0
    ds_write_b64 v4, v[4:5] offset:8640
    ds_write_b64 v4, v[4:5] offset:8648
    ds_write_b64 v4, v[4:5] offset:8656
    ds_write_b64 v4, v[4:5] offset:8664
    ds_write_b64 v4, v[4:5] offset:8672
    v_mul_u32_u24 v9, 10, v1
    v_mul_u32_u24 v7, 12288, v9
    v_add_u32 v7, v7, v3
    s_mul_i32 s56, s5, 983040
    s_mul_i32 s57, s4, 384
    s_add_u32 s56, s56, s57
    s_waitcnt lgkmcnt(0)
    buffer_load_dwordx4 v[88:91], v7, s[12:15], s56 offen offset:0 nt
    buffer_load_dwordx4 v[92:95], v7, s[12:15], s56 offen offset:128 nt
    buffer_load_dwordx4 v[96:99], v7, s[12:15], s56 offen offset:256 nt
    s_add_u32 s56, s56, 12288
    buffer_load_dwordx4 v[100:103], v7, s[12:15], s56 offen offset:0 nt
    buffer_load_dwordx4 v[104:107], v7, s[12:15], s56 offen offset:128 nt
    buffer_load_dwordx4 v[108:111], v7, s[12:15], s56 offen offset:256 nt
    s_add_u32 s56, s56, 12288
    buffer_load_dwordx4 v[112:115], v7, s[12:15], s56 offen offset:0 nt
    buffer_load_dwordx4 v[116:119], v7, s[12:15], s56 offen offset:128 nt
    buffer_load_dwordx4 v[120:123], v7, s[12:15], s56 offen offset:256 nt
    s_add_u32 s56, s56, 12288
    buffer_load_dwordx4 v[124:127], v7, s[12:15], s56 offen offset:0 nt
    buffer_load_dwordx4 v[128:131], v7, s[12:15], s56 offen offset:128 nt
    buffer_load_dwordx4 v[132:135], v7, s[12:15], s56 offen offset:256 nt
    s_add_u32 s56, s56, 12288
    buffer_load_dwordx4 v[136:139], v7, s[12:15], s56 offen offset:0 nt
    buffer_load_dwordx4 v[140:143], v7, s[12:15], s56 offen offset:128 nt
    buffer_load_dwordx4 v[144:147], v7, s[12:15], s56 offen offset:256 nt
    s_add_u32 s56, s56, 12288
    buffer_load_dwordx4 v[148:151], v7, s[12:15], s56 offen offset:0 nt
    buffer_load_dwordx4 v[152:155], v7, s[12:15], s56 offen offset:128 nt
    buffer_load_dwordx4 v[156:159], v7, s[12:15], s56 offen offset:256 nt
    s_add_u32 s56, s56, 12288
    buffer_load_dwordx4 v[160:163], v7, s[12:15], s56 offen offset:0 nt
    buffer_load_dwordx4 v[164:167], v7, s[12:15], s56 offen offset:128 nt
    buffer_load_dwordx4 v[168:171], v7, s[12:15], s56 offen offset:256 nt
    s_add_u32 s56, s56, 12288
    buffer_load_dwordx4 v[172:175], v7, s[12:15], s56 offen offset:0 nt
    buffer_load_dwordx4 v[176:179], v7, s[12:15], s56 offen offset:128 nt
    buffer_load_dwordx4 v[180:183], v7, s[12:15], s56 offen offset:256 nt
    s_add_u32 s56, s56, 12288
    buffer_load_dwordx4 v[184:187], v7, s[12:15], s56 offen offset:0 nt
    buffer_load_dwordx4 v[188:191], v7, s[12:15], s56 offen offset:128 nt
    buffer_load_dwordx4 v[192:195], v7, s[12:15], s56 offen offset:256 nt
    s_add_u32 s56, s56, 12288
    buffer_load_dwordx4 v[196:199], v7, s[12:15], s56 offen offset:0 nt
    buffer_load_dwordx4 v[200:203], v7, s[12:15], s56 offen offset:128 nt
    buffer_load_dwordx4 v[204:207], v7, s[12:15], s56 offen offset:256 nt
    s_barrier
    s_mul_i32 s6, s6, 0x9e3779b1
    s_add_u32 s6, s6, 0x7f4a7c15
    v_and_b32 v36, 1, v0
    v_lshlrev_b32 v36, 4, v36
    v_mov_b32 v37, 0xffff
    v_lshlrev_b32 v39, v36, v37
    v_bfe_u32 v38, v0, 1, 2
    v_cmp_eq_u32 vcc, 0, v38
    v_cmp_eq_u32 s[58:59], 1, v38
    s_nop 1
    v_cndmask_b32 v36, 0, v39, vcc
    v_cndmask_b32 v37, 0, v39, s[58:59]
    v_cmp_eq_u32 vcc, 2, v38
    v_cmp_eq_u32 s[58:59], 3, v38
    s_nop 1
    v_cndmask_b32 v38, 0, v39, vcc
    v_cndmask_b32 v39, 0, v39, s[58:59]
    s_cmp_lg_u32 s5, 0
    s_cbranch_scc1 L_s2_nz
    s_lshl_b32 s56, s4, 8
    s_add_u32 s56, s56, 4096
    s_mov_b64 exec, 1
    buffer_store_dword v4, v4, s[44:47], s56 offen sc1
    buffer_store_dword v4, v4, s[44:47], s56 offen offset:128 sc1
    s_mov_b64 exec, -1
L_s2_nz:
    v_lshlrev_b32 v9, 2, v9
    v_bfe_u32 v5, v0, 4, 1
    v_lshlrev_b32 v5, 3, v5
    v_and_b32 v8, 7, v0
    v_add_u32 v8, v8, v5
    v_lshlrev_b32 v8, 4, v8
    v_lshrrev_b32 v5, 5, v0
    v_mul_u32_u24 v5, 768, v5
    v_add_u32 v8, v8, v5
    v_mul_u32_u24 v5, 12, v0
    v_add_u32 v5, 8704, v5
    v_lshlrev_b32 v6, 4, v0
    s_lshl_b32 s56, s2, 10
    s_add_u32 s56, s56, 196608
    v_mov_b32 v47, s6
    s_waitcnt vmcnt(0)
    s_mov_b32 s57, 320000
L_w_65:
    ds_read_b32 v10, v4 offset:8640
    s_sub_u32 s57, s57, 1
    s_waitcnt lgkmcnt(0)
    v_readfirstlane_b32 s7, v10
    s_cmp_eq_u32 s57, 0
    s_cbranch_scc1 L_wok_66
    s_cmp_ge_u32 s7, 1
    s_cbranch_scc1 L_wok_66
    s_sleep 1
    s_branch L_w_65
L_wok_66:
    ds_read_b64 v[10:11], v9 offset:8192
    ds_read_b64 v[12:13], v9 offset:8200
    ds_read_b64 v[14:15], v9 offset:8208
    ds_read_b64 v[16:17], v9 offset:8216
    ds_read_b64 v[18:19], v9 offset:8224
    s_waitcnt lgkmcnt(0)
    v_and_b32 v32, v10, v36
    v_and_b32 v33, v10, v37
    v_and_b32 v34, v10, v38
    v_and_b32 v35, v10, v39
    s_nop 1
    v_mfma_f32_16x16x32_bf16 v[20:23], v[88:91], v[32:35], 0
    v_mfma_f32_16x16x32_bf16 v[24:27], v[92:95], v[32:35], 0
    v_mfma_f32_16x16x32_bf16 v[28:31], v[96:99], v[32:35], 0
    v_and_b32 v40, v11, v36
    v_and_b32 v41, v11, v37
    v_and_b32 v42, v11, v38
    v_and_b32 v43, v11, v39
    s_nop 1
    v_mfma_f32_16x16x32_bf16 v[20:23], v[100:103], v[40:43], v[20:23]
    v_mfma_f32_16x16x32_bf16 v[24:27], v[104:107], v[40:43], v[24:27]
    v_mfma_f32_16x16x32_bf16 v[28:31], v[108:111], v[40:43], v[28:31]
    v_and_b32 v32, v12, v36
    v_and_b32 v33, v12, v37
    v_and_b32 v34, v12, v38
    v_and_b32 v35, v12, v39
    s_nop 1
    v_mfma_f32_16x16x32_bf16 v[20:23], v[112:115], v[32:35], v[20:23]
    v_mfma_f32_16x16x32_bf16 v[24:27], v[116:119], v[32:35], v[24:27]
    v_mfma_f32_16x16x32_bf16 v[28:31], v[120:123], v[32:35], v[28:31]
    v_and_b32 v40, v13, v36
    v_and_b32 v41, v13, v37
    v_and_b32 v42, v13, v38
    v_and_b32 v43, v13, v39
    s_nop 1
    v_mfma_f32_16x16x32_bf16 v[20:23], v[124:127], v[40:43], v[20:23]
    v_mfma_f32_16x16x32_bf16 v[24:27], v[128:131], v[40:43], v[24:27]
    v_mfma_f32_16x16x32_bf16 v[28:31], v[132:135], v[40:43], v[28:31]
    v_and_b32 v32, v14, v36
    v_and_b32 v33, v14, v37
    v_and_b32 v34, v14, v38
    v_and_b32 v35, v14, v39
    s_nop 1
    v_mfma_f32_16x16x32_bf16 v[20:23], v[136:139], v[32:35], v[20:23]
    v_mfma_f32_16x16x32_bf16 v[24:27], v[140:143], v[32:35], v[24:27]
    v_mfma_f32_16x16x32_bf16 v[28:31], v[144:147], v[32:35], v[28:31]
    v_and_b32 v40, v15, v36
    v_and_b32 v41, v15, v37
    v_and_b32 v42, v15, v38
    v_and_b32 v43, v15, v39
    s_nop 1
    v_mfma_f32_16x16x32_bf16 v[20:23], v[148:151], v[40:43], v[20:23]
    v_mfma_f32_16x16x32_bf16 v[24:27], v[152:155], v[40:43], v[24:27]
    v_mfma_f32_16x16x32_bf16 v[28:31], v[156:159], v[40:43], v[28:31]
    v_and_b32 v32, v16, v36
    v_and_b32 v33, v16, v37
    v_and_b32 v34, v16, v38
    v_and_b32 v35, v16, v39
    s_nop 1
    v_mfma_f32_16x16x32_bf16 v[20:23], v[160:163], v[32:35], v[20:23]
    v_mfma_f32_16x16x32_bf16 v[24:27], v[164:167], v[32:35], v[24:27]
    v_mfma_f32_16x16x32_bf16 v[28:31], v[168:171], v[32:35], v[28:31]
    v_and_b32 v40, v17, v36
    v_and_b32 v41, v17, v37
    v_and_b32 v42, v17, v38
    v_and_b32 v43, v17, v39
    s_nop 1
    v_mfma_f32_16x16x32_bf16 v[20:23], v[172:175], v[40:43], v[20:23]
    v_mfma_f32_16x16x32_bf16 v[24:27], v[176:179], v[40:43], v[24:27]
    v_mfma_f32_16x16x32_bf16 v[28:31], v[180:183], v[40:43], v[28:31]
    v_and_b32 v32, v18, v36
    v_and_b32 v33, v18, v37
    v_and_b32 v34, v18, v38
    v_and_b32 v35, v18, v39
    s_nop 1
    v_mfma_f32_16x16x32_bf16 v[20:23], v[184:187], v[32:35], v[20:23]
    v_mfma_f32_16x16x32_bf16 v[24:27], v[188:191], v[32:35], v[24:27]
    v_mfma_f32_16x16x32_bf16 v[28:31], v[192:195], v[32:35], v[28:31]
    v_and_b32 v40, v19, v36
    v_and_b32 v41, v19, v37
    v_and_b32 v42, v19, v38
    v_and_b32 v43, v19, v39
    s_nop 1
    v_mfma_f32_16x16x32_bf16 v[20:23], v[196:199], v[40:43], v[20:23]
    v_mfma_f32_16x16x32_bf16 v[24:27], v[200:203], v[40:43], v[24:27]
    v_mfma_f32_16x16x32_bf16 v[28:31], v[204:207], v[40:43], v[28:31]
    s_nop 5
    s_mov_b32 exec_lo, 0x00ff00ff
    s_mov_b32 exec_hi, 0xff00ff00
    ds_write_b128 v8, v[20:23] offset:8704
    ds_write_b128 v8, v[24:27] offset:8960
    ds_write_b128 v8, v[28:31] offset:9216
    s_mov_b64 exec, -1
    ds_read2_b32 v[44:45], v5 offset0:0 offset1:1
    ds_read_b32 v46, v5 offset:8
    ds_read2_b32 v[12:13], v5 offset0:192 offset1:193
    ds_read_b32 v14, v5 offset:776
    s_waitcnt lgkmcnt(0)
    v_add_f32 v44, v44, v12
    v_add_f32 v45, v45, v13
    v_add_f32 v46, v46, v14
    buffer_store_dwordx4 v[44:47], v6, s[44:47], s56 offen sc1
    v_mov_b32 v10, 2
    ds_write_b32 v4, v10 offset:8640
    s_nop 1
L_pro_done:
    s_setprio 0
    s_getpc_b64 s[54:55]
        L_pc_66:
    s_add_u32 s54, s54, L_table - L_pc_66
    s_addc_u32 s55, s55, 0
    s_and_b32 s56, s2, 0xfc
    s_load_dword s53, s[54:55], s56
    s_mul_i32 s42, s3, 5120
    s_add_u32 s42, s42, 42496
    v_lshl_add_u32 v44, v0, 4, s42
    v_lshrrev_b32 v46, 4, v0
    v_lshlrev_b32 v46, 3, v46
    v_bfe_u32 v47, v0, 2, 2
    v_add_u32 v46, v46, v47
    v_and_b32 v47, 3, v0
    v_lshl_add_u32 v47, v47, 3, s42
    v_lshl_add_u32 v45, v46, 7, v47
    s_waitcnt lgkmcnt(0)
    s_and_b32 s56, s2, 3
    s_lshl_b32 s56, s56, 3
    s_lshr_b32 s53, s53, s56
    s_and_b32 s53, s53, 0xff
    s_cmp_lt_u32 s53, 160
    s_cselect_b32 s52, 1, 2
    s_cmp_eq_u32 s53, 255
    s_cselect_b32 s52, 0, s52
    s_cmp_eq_u32 s52, 1
    s_cbranch_scc1 L_wo
    s_cmp_eq_u32 s52, 2
    s_cbranch_scc1 L_mlp
    s_branch L_exit
L_wo:
    s_mul_i32 s43, s53, 6554
    s_lshr_b32 s43, s43, 16
    s_mul_i32 s56, s43, 10
    s_sub_u32 s42, s53, s56
    s_lshr_b32 s60, s3, 1
    s_lshl_b32 s61, s43, 1
    s_add_u32 s60, s60, s61
    s_and_b32 s61, s3, 1
    s_mul_i32 s62, s61, 96
    s_mul_i32 s56, s60, 192
    s_add_u32 s56, s56, s62
    s_mul_i32 s56, s56, 1280
    s_lshl_b32 s57, s42, 7
    s_add_u32 s56, s56, s57
    v_mul_u32_u24 v5, 1280, v1
    v_add_u32 v5, v5, v3
    s_mov_b32 s12, s24
    s_mov_b32 s13, s25
    s_mov_b32 s14, 7864320
    s_mov_b32 s15, 0x20000
    s_mov_b32 s67, s56
    v_mov_b32 v22, v5
    v_lshrrev_b32 v4, 5, v0
    v_and_b32 v5, 31, v0
    s_lshl_b32 s57, s61, 9
    v_lshlrev_b32 v24, 4, v5
    v_lshl_add_u32 v24, v4, 10, v24
    v_add_u32 v24, s57, v24
    v_lshlrev_b32 v25, 7, v4
    s_lshl_b32 s63, s60, 13
    s_add_u32 s63, s63, 524288
    s_add_u32 s66, s63, 4096
    s_lshl_b32 s64, s60, 10
    s_add_u32 s64, s64, 786432
    s_mul_i32 s57, s3, 192
    s_add_u32 s57, s57, 10240
    v_mul_u32_u24 v6, 3, v5
    v_and_b32 v8, 3, v6
    v_lshlrev_b32 v8, 3, v8
    v_and_b32 v7, 0xffffffe0, v6
    v_or_b32 v7, v7, v8
    v_bfe_u32 v8, v6, 2, 3
    v_or_b32 v7, v7, v8
    v_lshl_add_u32 v26, v7, 1, s57
    v_add_u32 v6, 1, v6
    v_and_b32 v8, 3, v6
    v_lshlrev_b32 v8, 3, v8
    v_and_b32 v7, 0xffffffe0, v6
    v_or_b32 v7, v7, v8
    v_bfe_u32 v8, v6, 2, 3
    v_or_b32 v7, v7, v8
    v_lshl_add_u32 v27, v7, 1, s57
    v_add_u32 v6, 1, v6
    v_and_b32 v8, 3, v6
    v_lshlrev_b32 v8, 3, v8
    v_and_b32 v7, 0xffffffe0, v6
    v_or_b32 v7, v7, v8
    v_bfe_u32 v8, v6, 2, 3
    v_or_b32 v7, v7, v8
    v_lshl_add_u32 v28, v7, 1, s57
    v_lshrrev_b32 v7, 4, v0
    v_lshl_add_u32 v29, v7, 4, s57
    v_and_b32 v7, 15, v0
    s_lshl_b32 s57, s3, 8
    v_lshl_add_u32 v30, v7, 2, s57
    v_min_u32 v6, 21, v0
    v_mul_u32_u24 v31, 12, v6
    v_lshlrev_b32 v23, 4, v6
    s_lshl_b32 s65, s43, 12
    s_mul_i32 s57, s42, 384
    s_add_u32 s65, s65, s57
    s_add_u32 s65, s65, 851968
    buffer_load_dwordx4 v[48:51], v22, s[12:15], s67 offen nt
    s_add_u32 s67, s67, 10240
    buffer_load_dwordx4 v[52:55], v22, s[12:15], s67 offen nt
    s_add_u32 s67, s67, 10240
    buffer_load_dwordx4 v[56:59], v22, s[12:15], s67 offen nt
    s_add_u32 s67, s67, 10240
    buffer_load_dwordx4 v[60:63], v22, s[12:15], s67 offen nt
    s_add_u32 s67, s67, 10240
    buffer_load_dwordx4 v[64:67], v22, s[12:15], s67 offen nt
    s_add_u32 s67, s67, 10240
    buffer_load_dwordx4 v[68:71], v22, s[12:15], s67 offen nt
    s_add_u32 s67, s67, 10240
    buffer_load_dwordx4 v[72:75], v22, s[12:15], s67 offen nt
    s_add_u32 s67, s67, 10240
    buffer_load_dwordx4 v[76:79], v22, s[12:15], s67 offen nt
    s_add_u32 s67, s67, 10240
    buffer_load_dwordx4 v[80:83], v22, s[12:15], s67 offen nt
    s_add_u32 s67, s67, 10240
    buffer_load_dwordx4 v[84:87], v22, s[12:15], s67 offen nt
    s_add_u32 s67, s67, 10240
    buffer_load_dwordx4 v[88:91], v22, s[12:15], s67 offen nt
    s_add_u32 s67, s67, 10240
    buffer_load_dwordx4 v[92:95], v22, s[12:15], s67 offen nt
    s_waitcnt vmcnt(8)
    ds_write_b128 v44, v[48:51] offset:0
    ds_write_b128 v44, v[52:55] offset:1024
    ds_write_b128 v44, v[56:59] offset:2048
    ds_write_b128 v44, v[60:63] offset:3072
    s_waitcnt lgkmcnt(0)
    ds_read_b64_tr_b16 v[48:49], v45 offset:0
    ds_read_b64_tr_b16 v[50:51], v45 offset:512
    ds_read_b64_tr_b16 v[52:53], v45 offset:32
    ds_read_b64_tr_b16 v[54:55], v45 offset:544
    ds_read_b64_tr_b16 v[56:57], v45 offset:64
    ds_read_b64_tr_b16 v[58:59], v45 offset:576
    ds_read_b64_tr_b16 v[60:61], v45 offset:96
    ds_read_b64_tr_b16 v[62:63], v45 offset:608
    s_waitcnt vmcnt(4)
    ds_write_b128 v44, v[64:67] offset:0
    ds_write_b128 v44, v[68:71] offset:1024
    ds_write_b128 v44, v[72:75] offset:2048
    ds_write_b128 v44, v[76:79] offset:3072
    s_waitcnt lgkmcnt(0)
    ds_read_b64_tr_b16 v[64:65], v45 offset:0
    ds_read_b64_tr_b16 v[66:67], v45 offset:512
    ds_read_b64_tr_b16 v[68:69], v45 offset:32
    ds_read_b64_tr_b16 v[70:71], v45 offset:544
    ds_read_b64_tr_b16 v[72:73], v45 offset:64
    ds_read_b64_tr_b16 v[74:75], v45 offset:576
    ds_read_b64_tr_b16 v[76:77], v45 offset:96
    ds_read_b64_tr_b16 v[78:79], v45 offset:608
    s_waitcnt vmcnt(0)
    ds_write_b128 v44, v[80:83] offset:0
    ds_write_b128 v44, v[84:87] offset:1024
    ds_write_b128 v44, v[88:91] offset:2048
    ds_write_b128 v44, v[92:95] offset:3072
    s_waitcnt lgkmcnt(0)
    ds_read_b64_tr_b16 v[80:81], v45 offset:0
    ds_read_b64_tr_b16 v[82:83], v45 offset:512
    ds_read_b64_tr_b16 v[84:85], v45 offset:32
    ds_read_b64_tr_b16 v[86:87], v45 offset:544
    ds_read_b64_tr_b16 v[88:89], v45 offset:64
    ds_read_b64_tr_b16 v[90:91], v45 offset:576
    ds_read_b64_tr_b16 v[92:93], v45 offset:96
    ds_read_b64_tr_b16 v[94:95], v45 offset:608
    s_waitcnt lgkmcnt(0)
    v_mov_b32 v32, 0
    s_mov_b32 s57, 320000
L_w_68:
    ds_read_b32 v33, v32 offset:8648
    s_sub_u32 s57, s57, 1
    s_waitcnt lgkmcnt(0)
    v_readfirstlane_b32 s7, v33
    s_cmp_eq_u32 s57, 0
    s_cbranch_scc1 L_wok_69
    s_cmp_ge_u32 s7, 5
    s_cbranch_scc1 L_wok_69
    s_sleep 2
    s_branch L_w_68
L_wok_69:
    s_setprio 3
    s_mov_b32 s57, 40000
    buffer_load_dwordx4 v[112:115], v24, s[44:47], s63 offen offset:0 sc1
    buffer_load_dwordx4 v[116:119], v24, s[44:47], s63 offen offset:2048 sc1
    buffer_load_dwordx4 v[120:123], v24, s[44:47], s66 offen offset:0 sc1
    buffer_load_dwordx4 v[124:127], v24, s[44:47], s66 offen offset:2048 sc1
    buffer_load_dwordx4 v[128:131], v25, s[44:47], s64 offen offset:0 sc1
    buffer_load_dwordx4 v[132:135], v25, s[44:47], s64 offen offset:256 sc1
    buffer_load_dwordx4 v[136:139], v25, s[44:47], s64 offen offset:512 sc1
    buffer_load_dwordx4 v[140:143], v25, s[44:47], s64 offen offset:768 sc1
L_poll_70:
    s_waitcnt vmcnt(0)
    v_xor_b32 v2, s6, v115
    v_bitop3_b32 v2, v2, v119, s6 bitop3:0xf6
    v_bitop3_b32 v2, v2, v123, s6 bitop3:0xf6
    v_bitop3_b32 v2, v2, v127, s6 bitop3:0xf6
    v_bitop3_b32 v2, v2, v131, s6 bitop3:0xf6
    v_bitop3_b32 v2, v2, v135, s6 bitop3:0xf6
    v_bitop3_b32 v2, v2, v139, s6 bitop3:0xf6
    v_bitop3_b32 v2, v2, v143, s6 bitop3:0xf6
    v_cmp_ne_u32 vcc, 0, v2
    s_cbranch_vccz L_ok_71
    v_cmp_ne_u32 s[16:17], s6, v115
    v_cmp_ne_u32 s[18:19], s6, v119
    v_cmp_ne_u32 s[20:21], s6, v123
    v_cmp_ne_u32 s[22:23], s6, v127
    v_cmp_ne_u32 s[24:25], s6, v131
    v_cmp_ne_u32 s[26:27], s6, v135
    v_cmp_ne_u32 s[28:29], s6, v139
    v_cmp_ne_u32 s[30:31], s6, v143
    s_sub_u32 s57, s57, 1
    s_cmp_eq_u32 s57, 0
    s_cbranch_scc1 L_ok_71
    s_cmp_eq_u64 s[16:17], 0
    s_cbranch_scc1 L_sk_72
    buffer_load_dwordx4 v[112:115], v24, s[44:47], s63 offen offset:0 sc1
L_sk_72:
    s_cmp_eq_u64 s[18:19], 0
    s_cbranch_scc1 L_sk_73
    buffer_load_dwordx4 v[116:119], v24, s[44:47], s63 offen offset:2048 sc1
L_sk_73:
    s_cmp_eq_u64 s[20:21], 0
    s_cbranch_scc1 L_sk_74
    buffer_load_dwordx4 v[120:123], v24, s[44:47], s66 offen offset:0 sc1
L_sk_74:
    s_cmp_eq_u64 s[22:23], 0
    s_cbranch_scc1 L_sk_75
    buffer_load_dwordx4 v[124:127], v24, s[44:47], s66 offen offset:2048 sc1
L_sk_75:
    s_cmp_eq_u64 s[24:25], 0
    s_cbranch_scc1 L_sk_76
    buffer_load_dwordx4 v[128:131], v25, s[44:47], s64 offen offset:0 sc1
L_sk_76:
    s_cmp_eq_u64 s[26:27], 0
    s_cbranch_scc1 L_sk_77
    buffer_load_dwordx4 v[132:135], v25, s[44:47], s64 offen offset:256 sc1
L_sk_77:
    s_cmp_eq_u64 s[28:29], 0
    s_cbranch_scc1 L_sk_78
    buffer_load_dwordx4 v[136:139], v25, s[44:47], s64 offen offset:512 sc1
L_sk_78:
    s_cmp_eq_u64 s[30:31], 0
    s_cbranch_scc1 L_sk_79
    buffer_load_dwordx4 v[140:143], v25, s[44:47], s64 offen offset:768 sc1
L_sk_79:
    s_branch L_poll_70
L_ok_71:
    v_max3_f32 v4, v128, v132, v136
    v_max_f32 v4, v4, v140
    v_mov_b32 v5, v4
    s_nop 1
    v_permlane32_swap_b32 v4, v5
    s_nop 0
    v_max_f32 v4, v4, v5
    v_sub_f32 v128, v128, v4
    v_sub_f32 v132, v132, v4
    v_sub_f32 v136, v136, v4
    v_sub_f32 v140, v140, v4
    v_mul_f32 v128, 0x3fb8aa3b, v128
    v_mul_f32 v132, 0x3fb8aa3b, v132
    v_mul_f32 v136, 0x3fb8aa3b, v136
    v_mul_f32 v140, 0x3fb8aa3b, v140
    v_exp_f32 v128, v128
    v_exp_f32 v132, v132
    v_exp_f32 v136, v136
    v_exp_f32 v140, v140
    v_mul_f32 v8, v128, v129
    v_mul_f32 v9, v128, v112
    v_mul_f32 v10, v128, v113
    v_mul_f32 v11, v128, v114
    v_fmac_f32 v8, v132, v133
    v_fmac_f32 v9, v132, v116
    v_fmac_f32 v10, v132, v117
    v_fmac_f32 v11, v132, v118
    v_fmac_f32 v8, v136, v137
    v_fmac_f32 v9, v136, v120
    v_fmac_f32 v10, v136, v121
    v_fmac_f32 v11, v136, v122
    v_fmac_f32 v8, v140, v141
    v_fmac_f32 v9, v140, v124
    v_fmac_f32 v10, v140, v125
    v_fmac_f32 v11, v140, v126
    v_mov_b32 v12, v8
    v_mov_b32 v13, v9
    v_mov_b32 v14, v10
    v_mov_b32 v15, v11
    s_nop 0
    v_permlane32_swap_b32 v8, v12
    v_permlane32_swap_b32 v9, v13
    v_permlane32_swap_b32 v10, v14
    s_nop 0
    v_permlane32_swap_b32 v11, v15
    v_add_f32 v8, v8, v12
    v_rcp_f32 v8, v8
    v_add_f32 v9, v9, v13
    v_add_f32 v10, v10, v14
    v_add_f32 v11, v11, v15
    v_mul_f32 v9, v9, v8
    v_mul_f32 v10, v10, v8
    v_mul_f32 v11, v11, v8
    v_cvt_pk_bf16_f32 v9, v9, v9
    ds_write_b16 v26, v9
    v_cvt_pk_bf16_f32 v10, v10, v10
    ds_write_b16 v27, v10
    v_cvt_pk_bf16_f32 v11, v11, v11
    ds_write_b16 v28, v11
    ds_read_b128 v[8:11], v29 offset:0
    ds_read_b128 v[12:15], v29 offset:64
    ds_read_b128 v[16:19], v29 offset:128
    s_waitcnt lgkmcnt(2)
    v_mfma_f32_16x16x32_bf16 v[96:99], v[8:11], v[48:51], 0
    v_mfma_f32_16x16x32_bf16 v[100:103], v[8:11], v[52:55], 0
    v_mfma_f32_16x16x32_bf16 v[104:107], v[8:11], v[56:59], 0
    v_mfma_f32_16x16x32_bf16 v[108:111], v[8:11], v[60:63], 0
    s_waitcnt lgkmcnt(1)
    v_mfma_f32_16x16x32_bf16 v[96:99], v[12:15], v[64:67], v[96:99]
    v_mfma_f32_16x16x32_bf16 v[100:103], v[12:15], v[68:71], v[100:103]
    v_mfma_f32_16x16x32_bf16 v[104:107], v[12:15], v[72:75], v[104:107]
    v_mfma_f32_16x16x32_bf16 v[108:111], v[12:15], v[76:79], v[108:111]
    s_waitcnt lgkmcnt(0)
    v_mfma_f32_16x16x32_bf16 v[96:99], v[16:19], v[80:83], v[96:99]
    v_mfma_f32_16x16x32_bf16 v[100:103], v[16:19], v[84:87], v[100:103]
    v_mfma_f32_16x16x32_bf16 v[104:107], v[16:19], v[88:91], v[104:107]
    v_mfma_f32_16x16x32_bf16 v[108:111], v[16:19], v[92:95], v[108:111]
    s_mov_b64 exec, 0xffff
    s_nop 3
    ds_write_b32 v30, v96 offset:11008
    ds_write_b32 v30, v100 offset:11072
    ds_write_b32 v30, v104 offset:11136
    ds_write_b32 v30, v108 offset:11200
    s_mov_b64 exec, -1
    s_waitcnt lgkmcnt(0)
    s_barrier
    s_cmp_lg_u32 s3, 0
    s_cbranch_scc1 L_exit
    v_add_u32 v31, 11008, v31
    ds_read2_b32 v[8:9], v31 offset0:0 offset1:1
    ds_read_b32 v10, v31 offset:8
    ds_read2_b32 v[12:13], v31 offset0:64 offset1:65
    ds_read_b32 v14, v31 offset:264
    ds_read2_b32 v[16:17], v31 offset0:128 offset1:129
    ds_read_b32 v18, v31 offset:520
    ds_read2_b32 v[20:21], v31 offset0:192 offset1:193
    ds_read_b32 v22, v31 offset:776
    v_mov_b32 v11, s6
    s_mov_b32 exec_lo, 0x3fffff
    s_mov_b32 exec_hi, 0
    s_waitcnt lgkmcnt(0)
    v_add_f32 v8, v8, v12
    v_add_f32 v9, v9, v13
    v_add_f32 v10, v10, v14
    v_add_f32 v16, v16, v20
    v_add_f32 v17, v17, v21
    v_add_f32 v18, v18, v22
    v_add_f32 v8, v8, v16
    v_add_f32 v9, v9, v17
    v_add_f32 v10, v10, v18
    buffer_store_dwordx4 v[8:11], v23, s[44:47], s65 offen sc1
    s_branch L_exit
L_mlp:
    s_setprio 1
    v_mov_b32 v32, 0
    s_mov_b32 s57, 320000
L_w_80:
    ds_read_b32 v33, v32 offset:8644
    s_sub_u32 s57, s57, 1
    s_waitcnt lgkmcnt(0)
    v_readfirstlane_b32 s7, v33
    s_cmp_eq_u32 s57, 0
    s_cbranch_scc1 L_wok_81
    s_cmp_ge_u32 s7, 1
    s_cbranch_scc1 L_wok_81
    s_sleep 8
    s_branch L_w_80
L_wok_81:
    s_mov_b32 s8, s16
    s_mov_b32 s9, s17
    s_mov_b32 s10, 1280
    s_mov_b32 s11, 0x20000
    v_lshlrev_b32 v6, 1, v0
    buffer_load_ushort v208, v6, s[8:11], 0 offen offset:0
    buffer_load_ushort v209, v6, s[8:11], 0 offen offset:128
    buffer_load_ushort v210, v6, s[8:11], 0 offen offset:256
    buffer_load_ushort v211, v6, s[8:11], 0 offen offset:384
    buffer_load_ushort v212, v6, s[8:11], 0 offen offset:512
    buffer_load_ushort v213, v6, s[8:11], 0 offen offset:640
    buffer_load_ushort v214, v6, s[8:11], 0 offen offset:768
    buffer_load_ushort v215, v6, s[8:11], 0 offen offset:896
    buffer_load_ushort v216, v6, s[8:11], 0 offen offset:1024
    buffer_load_ushort v217, v6, s[8:11], 0 offen offset:1152
    s_mul_i32 s42, s3, 3840
    s_add_u32 s42, s42, 24064
    s_mul_i32 s43, s3, 2560
    s_add_u32 s43, s43, 12288
    s_mov_b32 s60, 2731
    v_mov_b32 v9, 27648
    v_add_u32 v4, 0, v0
    v_min_u32 v4, 239, v4
    v_mul_u32_u24 v5, s60, v4
    v_lshrrev_b32 v5, 16, v5
    v_mul_u32_u24 v6, 24, v5
    v_sub_u32 v6, v4, v6
    v_min_u32 v6, 21, v6
    v_mul_u32_u24 v7, 384, v5
    v_lshl_add_u32 v20, v6, 4, v7
    v_cmp_gt_u32 vcc, 21, v6
    v_mul_u32_u24 v6, 12, v6
    v_lshl_add_u32 v6, v5, 8, v6
    v_add_u32 v24, s43, v6
    v_add_u32 v6, 4, v24
    v_cndmask_b32 v25, v9, v6, vcc
    v_add_u32 v4, 64, v0
    v_min_u32 v4, 239, v4
    v_mul_u32_u24 v5, s60, v4
    v_lshrrev_b32 v5, 16, v5
    v_mul_u32_u24 v6, 24, v5
    v_sub_u32 v6, v4, v6
    v_min_u32 v6, 21, v6
    v_mul_u32_u24 v7, 384, v5
    v_lshl_add_u32 v21, v6, 4, v7
    v_cmp_gt_u32 vcc, 21, v6
    v_mul_u32_u24 v6, 12, v6
    v_lshl_add_u32 v6, v5, 8, v6
    v_add_u32 v26, s43, v6
    v_add_u32 v6, 4, v26
    v_cndmask_b32 v27, v9, v6, vcc
    v_add_u32 v4, 128, v0
    v_min_u32 v4, 239, v4
    v_mul_u32_u24 v5, s60, v4
    v_lshrrev_b32 v5, 16, v5
    v_mul_u32_u24 v6, 24, v5
    v_sub_u32 v6, v4, v6
    v_min_u32 v6, 21, v6
    v_mul_u32_u24 v7, 384, v5
    v_lshl_add_u32 v22, v6, 4, v7
    v_cmp_gt_u32 vcc, 21, v6
    v_mul_u32_u24 v6, 12, v6
    v_lshl_add_u32 v6, v5, 8, v6
    v_add_u32 v28, s43, v6
    v_add_u32 v6, 4, v28
    v_cndmask_b32 v29, v9, v6, vcc
    v_add_u32 v4, 192, v0
    v_min_u32 v4, 239, v4
    v_mul_u32_u24 v5, s60, v4
    v_lshrrev_b32 v5, 16, v5
    v_mul_u32_u24 v6, 24, v5
    v_sub_u32 v6, v4, v6
    v_min_u32 v6, 21, v6
    v_mul_u32_u24 v7, 384, v5
    v_lshl_add_u32 v23, v6, 4, v7
    v_cmp_gt_u32 vcc, 21, v6
    v_mul_u32_u24 v6, 12, v6
    v_lshl_add_u32 v6, v5, 8, v6
    v_add_u32 v30, s43, v6
    v_add_u32 v6, 4, v30
    v_cndmask_b32 v31, v9, v6, vcc
    s_mov_b32 s57, 40000
L_poll_82:
    s_add_u32 s56, s42, 0
    buffer_load_dwordx4 v[48:51], v20, s[44:47], s56 offen sc1
    buffer_load_dwordx4 v[52:55], v21, s[44:47], s56 offen sc1
    buffer_load_dwordx4 v[56:59], v22, s[44:47], s56 offen sc1
    buffer_load_dwordx4 v[60:63], v23, s[44:47], s56 offen sc1
    s_add_u32 s56, s42, 23040
    buffer_load_dwordx4 v[64:67], v20, s[44:47], s56 offen sc1
    buffer_load_dwordx4 v[68:71], v21, s[44:47], s56 offen sc1
    buffer_load_dwordx4 v[72:75], v22, s[44:47], s56 offen sc1
    buffer_load_dwordx4 v[76:79], v23, s[44:47], s56 offen sc1
    s_add_u32 s56, s42, 46080
    buffer_load_dwordx4 v[80:83], v20, s[44:47], s56 offen sc1
    buffer_load_dwordx4 v[84:87], v21, s[44:47], s56 offen sc1
    buffer_load_dwordx4 v[88:91], v22, s[44:47], s56 offen sc1
    buffer_load_dwordx4 v[92:95], v23, s[44:47], s56 offen sc1
    s_add_u32 s56, s42, 69120
    buffer_load_dwordx4 v[96:99], v20, s[44:47], s56 offen sc1
    buffer_load_dwordx4 v[100:103], v21, s[44:47], s56 offen sc1
    buffer_load_dwordx4 v[104:107], v22, s[44:47], s56 offen sc1
    buffer_load_dwordx4 v[108:111], v23, s[44:47], s56 offen sc1
    s_sub_u32 s57, s57, 1
    s_waitcnt vmcnt(0)
    v_xor_b32 v5, s6, v51
    v_bitop3_b32 v5, v5, v55, s6 bitop3:0xf6
    v_bitop3_b32 v5, v5, v59, s6 bitop3:0xf6
    v_bitop3_b32 v5, v5, v63, s6 bitop3:0xf6
    v_bitop3_b32 v5, v5, v67, s6 bitop3:0xf6
    v_bitop3_b32 v5, v5, v71, s6 bitop3:0xf6
    v_bitop3_b32 v5, v5, v75, s6 bitop3:0xf6
    v_bitop3_b32 v5, v5, v79, s6 bitop3:0xf6
    v_bitop3_b32 v5, v5, v83, s6 bitop3:0xf6
    v_bitop3_b32 v5, v5, v87, s6 bitop3:0xf6
    v_bitop3_b32 v5, v5, v91, s6 bitop3:0xf6
    v_bitop3_b32 v5, v5, v95, s6 bitop3:0xf6
    v_bitop3_b32 v5, v5, v99, s6 bitop3:0xf6
    v_bitop3_b32 v5, v5, v103, s6 bitop3:0xf6
    v_bitop3_b32 v5, v5, v107, s6 bitop3:0xf6
    v_bitop3_b32 v5, v5, v111, s6 bitop3:0xf6
    v_cmp_ne_u32 vcc, 0, v5
    s_cbranch_vccz L_ok_83
    s_cmp_eq_u32 s57, 0
    s_cbranch_scc1 L_ok_83
    s_sleep 1
    s_branch L_poll_82
L_ok_83:
    v_lshlrev_b32 v14, 2, v0
    s_cmp_eq_u32 s3, 2
    s_cselect_b32 s57, 1.0, 0
    s_cselect_b32 s62, 0, 1344
    s_add_u32 s62, s62, 144896
    v_add_f32 v48, v48, v64
    v_add_f32 v80, v80, v96
    v_add_f32 v48, v48, v80
    v_cvt_pk_bf16_f32 v48, v48, v48
    v_lshlrev_b32 v48, 16, v48
    v_add_f32 v48, s57, v48
    v_cvt_pk_bf16_f32 v48, v48, v48
    v_lshlrev_b32 v48, 16, v48
    v_add_f32 v49, v49, v65
    v_add_f32 v81, v81, v97
    v_add_f32 v49, v49, v81
    v_cvt_pk_bf16_f32 v49, v49, v49
    v_lshlrev_b32 v49, 16, v49
    v_add_f32 v49, s57, v49
    v_cvt_pk_bf16_f32 v49, v49, v49
    v_lshlrev_b32 v49, 16, v49
    v_add_f32 v50, v50, v66
    v_add_f32 v82, v82, v98
    v_add_f32 v50, v50, v82
    v_cvt_pk_bf16_f32 v50, v50, v50
    v_lshlrev_b32 v50, 16, v50
    v_add_f32 v50, s57, v50
    v_cvt_pk_bf16_f32 v50, v50, v50
    v_lshlrev_b32 v50, 16, v50
    ds_write_b32 v24, v48
    ds_write2_b32 v25, v49, v50 offset0:0 offset1:1
    s_sub_u32 s56, s3, 1
    s_cmp_gt_u32 s56, 1
    s_cbranch_scc1 L_pk_84
    v_subrev_u32 v4, s43, v24
    v_lshrrev_b32 v4, 1, v4
    v_add_u32 v4, s62, v4
    v_cmp_ne_u32 vcc, v9, v25
    ds_write_b16_d16_hi v4, v48
    s_and_saveexec_b64 s[58:59], vcc
    ds_write_b16_d16_hi v4, v49 offset:2
    ds_write_b16_d16_hi v4, v50 offset:4
    s_mov_b64 exec, -1
    s_waitcnt lgkmcnt(0)
L_pk_84:
    v_add_f32 v52, v52, v68
    v_add_f32 v84, v84, v100
    v_add_f32 v52, v52, v84
    v_cvt_pk_bf16_f32 v52, v52, v52
    v_lshlrev_b32 v52, 16, v52
    v_add_f32 v52, s57, v52
    v_cvt_pk_bf16_f32 v52, v52, v52
    v_lshlrev_b32 v52, 16, v52
    v_add_f32 v53, v53, v69
    v_add_f32 v85, v85, v101
    v_add_f32 v53, v53, v85
    v_cvt_pk_bf16_f32 v53, v53, v53
    v_lshlrev_b32 v53, 16, v53
    v_add_f32 v53, s57, v53
    v_cvt_pk_bf16_f32 v53, v53, v53
    v_lshlrev_b32 v53, 16, v53
    v_add_f32 v54, v54, v70
    v_add_f32 v86, v86, v102
    v_add_f32 v54, v54, v86
    v_cvt_pk_bf16_f32 v54, v54, v54
    v_lshlrev_b32 v54, 16, v54
    v_add_f32 v54, s57, v54
    v_cvt_pk_bf16_f32 v54, v54, v54
    v_lshlrev_b32 v54, 16, v54
    ds_write_b32 v26, v52
    ds_write2_b32 v27, v53, v54 offset0:0 offset1:1
    s_sub_u32 s56, s3, 1
    s_cmp_gt_u32 s56, 1
    s_cbranch_scc1 L_pk_85
    v_subrev_u32 v4, s43, v26
    v_lshrrev_b32 v4, 1, v4
    v_add_u32 v4, s62, v4
    v_cmp_ne_u32 vcc, v9, v27
    ds_write_b16_d16_hi v4, v52
    s_and_saveexec_b64 s[58:59], vcc
    ds_write_b16_d16_hi v4, v53 offset:2
    ds_write_b16_d16_hi v4, v54 offset:4
    s_mov_b64 exec, -1
    s_waitcnt lgkmcnt(0)
L_pk_85:
    v_add_f32 v56, v56, v72
    v_add_f32 v88, v88, v104
    v_add_f32 v56, v56, v88
    v_cvt_pk_bf16_f32 v56, v56, v56
    v_lshlrev_b32 v56, 16, v56
    v_add_f32 v56, s57, v56
    v_cvt_pk_bf16_f32 v56, v56, v56
    v_lshlrev_b32 v56, 16, v56
    v_add_f32 v57, v57, v73
    v_add_f32 v89, v89, v105
    v_add_f32 v57, v57, v89
    v_cvt_pk_bf16_f32 v57, v57, v57
    v_lshlrev_b32 v57, 16, v57
    v_add_f32 v57, s57, v57
    v_cvt_pk_bf16_f32 v57, v57, v57
    v_lshlrev_b32 v57, 16, v57
    v_add_f32 v58, v58, v74
    v_add_f32 v90, v90, v106
    v_add_f32 v58, v58, v90
    v_cvt_pk_bf16_f32 v58, v58, v58
    v_lshlrev_b32 v58, 16, v58
    v_add_f32 v58, s57, v58
    v_cvt_pk_bf16_f32 v58, v58, v58
    v_lshlrev_b32 v58, 16, v58
    ds_write_b32 v28, v56
    ds_write2_b32 v29, v57, v58 offset0:0 offset1:1
    s_sub_u32 s56, s3, 1
    s_cmp_gt_u32 s56, 1
    s_cbranch_scc1 L_pk_86
    v_subrev_u32 v4, s43, v28
    v_lshrrev_b32 v4, 1, v4
    v_add_u32 v4, s62, v4
    v_cmp_ne_u32 vcc, v9, v29
    ds_write_b16_d16_hi v4, v56
    s_and_saveexec_b64 s[58:59], vcc
    ds_write_b16_d16_hi v4, v57 offset:2
    ds_write_b16_d16_hi v4, v58 offset:4
    s_mov_b64 exec, -1
    s_waitcnt lgkmcnt(0)
L_pk_86:
    v_add_f32 v60, v60, v76
    v_add_f32 v92, v92, v108
    v_add_f32 v60, v60, v92
    v_cvt_pk_bf16_f32 v60, v60, v60
    v_lshlrev_b32 v60, 16, v60
    v_add_f32 v60, s57, v60
    v_cvt_pk_bf16_f32 v60, v60, v60
    v_lshlrev_b32 v60, 16, v60
    v_add_f32 v61, v61, v77
    v_add_f32 v93, v93, v109
    v_add_f32 v61, v61, v93
    v_cvt_pk_bf16_f32 v61, v61, v61
    v_lshlrev_b32 v61, 16, v61
    v_add_f32 v61, s57, v61
    v_cvt_pk_bf16_f32 v61, v61, v61
    v_lshlrev_b32 v61, 16, v61
    v_add_f32 v62, v62, v78
    v_add_f32 v94, v94, v110
    v_add_f32 v62, v62, v94
    v_cvt_pk_bf16_f32 v62, v62, v62
    v_lshlrev_b32 v62, 16, v62
    v_add_f32 v62, s57, v62
    v_cvt_pk_bf16_f32 v62, v62, v62
    v_lshlrev_b32 v62, 16, v62
    ds_write_b32 v30, v60
    ds_write2_b32 v31, v61, v62 offset0:0 offset1:1
    s_sub_u32 s56, s3, 1
    s_cmp_gt_u32 s56, 1
    s_cbranch_scc1 L_pk_87
    v_subrev_u32 v4, s43, v30
    v_lshrrev_b32 v4, 1, v4
    v_add_u32 v4, s62, v4
    v_cmp_ne_u32 vcc, v9, v31
    ds_write_b16_d16_hi v4, v60
    s_and_saveexec_b64 s[58:59], vcc
    ds_write_b16_d16_hi v4, v61 offset:2
    ds_write_b16_d16_hi v4, v62 offset:4
    s_mov_b64 exec, -1
    s_waitcnt lgkmcnt(0)
L_pk_87:
    s_waitcnt lgkmcnt(0)
    v_lshlrev_b32 v208, 16, v208
    ds_write_b32 v14, v208 offset:22528
    v_lshlrev_b32 v209, 16, v209
    ds_write_b32 v14, v209 offset:22784
    v_lshlrev_b32 v210, 16, v210
    ds_write_b32 v14, v210 offset:23040
    v_lshlrev_b32 v211, 16, v211
    ds_write_b32 v14, v211 offset:23296
    v_lshlrev_b32 v212, 16, v212
    ds_write_b32 v14, v212 offset:23552
    v_lshlrev_b32 v213, 16, v213
    ds_write_b32 v14, v213 offset:23808
    v_lshlrev_b32 v214, 16, v214
    ds_write_b32 v14, v214 offset:24064
    v_lshlrev_b32 v215, 16, v215
    ds_write_b32 v14, v215 offset:24320
    v_lshlrev_b32 v216, 16, v216
    ds_write_b32 v14, v216 offset:24576
    v_lshlrev_b32 v217, 16, v217
    ds_write_b32 v14, v217 offset:24832
    v_mov_b32 v4, 0
    v_mov_b32 v5, 1
    s_mov_b64 exec, 1
    s_waitcnt lgkmcnt(0)
    ds_add_u32 v4, v5 offset:8652
    s_mov_b64 exec, -1
    s_mul_i32 s57, s3, 640
    v_add_u32 v10, s57, v14
    v_and_b32 v28, 31, v0
    v_lshlrev_b32 v28, 2, v28
    s_add_u32 s57, s57, 512
    v_add_u32 v19, s57, v28
    s_mul_i32 s57, s3, 384
    s_add_u32 s57, s57, 27904
    v_lshl_add_u32 v11, v0, 1, s57
    v_lshrrev_b32 v28, 4, v0
    v_lshl_add_u32 v12, v28, 4, s57
    s_lshl_b32 s57, s3, 7
    s_add_u32 s57, s57, 30464
    v_lshl_add_u32 v15, v0, 1, s57
    v_lshl_add_u32 v16, v28, 4, s57
    v_cmp_eq_u32 s[94:95], 1, v28
    v_cmp_eq_u32 s[96:97], 2, v28
    v_cmp_eq_u32 s[98:99], 3, v28
    v_and_b32 v28, 15, v0
    s_lshl_b32 s57, s3, 8
    v_lshl_add_u32 v13, v28, 2, s57
    s_lshl_b32 s57, s3, 10
    v_lshl_add_u32 v17, v0, 4, s57
    s_lshl_b32 s60, s4, 12
    s_add_u32 s61, s60, 1114112
    s_add_u32 s60, s60, 983040
    v_mul_u32_u24 v46, 160, v46
    v_add_u32 v46, v46, v47
    v_mov_b32 v18, 0
    v_and_b32 v28, 1, v0
    v_mul_u32_u24 v28, 1344, v28
    v_lshrrev_b32 v29, 4, v0
    v_lshl_add_u32 v12, v29, 4, v28
    v_lshlrev_b32 v16, 4, v29
    v_add_u32 v16, 30592, v16
    v_and_b32 v28, 15, v0
    s_lshl_b32 s57, s3, 5
    s_add_u32 s57, s57, 30592
    v_lshl_add_u32 v15, v28, 1, s57
    s_mul_i32 s57, s3, 20480
    s_add_u32 s57, s57, 62976
    v_lshl_add_u32 v10, v0, 4, s57
    s_mul_i32 s57, s3, 5120
    s_add_u32 s57, s57, 42496
    v_subrev_u32 v11, s57, v45
    s_lshl_b32 s57, s3, 5
    s_add_u32 s57, s57, 62976
    v_add_u32 v11, s57, v11
    v_add_u32 v13, 40960, v11
    s_mov_b32 s12, s28
    s_mov_b32 s13, s29
    s_mov_b32 s14, 1966080
    s_mov_b32 s15, 0x20000
    s_mov_b32 s48, s30
    s_mov_b32 s49, s31
    s_mov_b32 s50, 1966080
    s_mov_b32 s51, 0x20000
    v_mul_u32_u24 v28, 3072, v1
    v_add_u32 v28, v28, v3
    s_mul_i32 s56, s3, 491520
    s_lshl_b32 s57, s4, 7
    s_add_u32 s56, s56, s57
    s_waitcnt lgkmcnt(0)
    buffer_load_dwordx4 v[48:51], v28, s[12:15], s56 offen nt
    s_add_u32 s56, s56, 24576
    buffer_load_dwordx4 v[52:55], v28, s[12:15], s56 offen nt
    s_add_u32 s56, s56, 24576
    buffer_load_dwordx4 v[56:59], v28, s[12:15], s56 offen nt
    s_add_u32 s56, s56, 24576
    buffer_load_dwordx4 v[60:63], v28, s[12:15], s56 offen nt
    s_add_u32 s56, s56, 24576
    buffer_load_dwordx4 v[64:67], v28, s[12:15], s56 offen nt
    s_add_u32 s56, s56, 24576
    buffer_load_dwordx4 v[68:71], v28, s[12:15], s56 offen nt
    s_add_u32 s56, s56, 24576
    buffer_load_dwordx4 v[72:75], v28, s[12:15], s56 offen nt
    s_add_u32 s56, s56, 24576
    buffer_load_dwordx4 v[76:79], v28, s[12:15], s56 offen nt
    s_add_u32 s56, s56, 24576
    buffer_load_dwordx4 v[80:83], v28, s[12:15], s56 offen nt
    s_add_u32 s56, s56, 24576
    buffer_load_dwordx4 v[84:87], v28, s[12:15], s56 offen nt
    s_add_u32 s56, s56, 24576
    buffer_load_dwordx4 v[88:91], v28, s[12:15], s56 offen nt
    s_add_u32 s56, s56, 24576
    buffer_load_dwordx4 v[92:95], v28, s[12:15], s56 offen nt
    s_add_u32 s56, s56, 24576
    buffer_load_dwordx4 v[96:99], v28, s[12:15], s56 offen nt
    s_add_u32 s56, s56, 24576
    buffer_load_dwordx4 v[100:103], v28, s[12:15], s56 offen nt
    s_add_u32 s56, s56, 24576
    buffer_load_dwordx4 v[104:107], v28, s[12:15], s56 offen nt
    s_add_u32 s56, s56, 24576
    buffer_load_dwordx4 v[108:111], v28, s[12:15], s56 offen nt
    s_add_u32 s56, s56, 24576
    buffer_load_dwordx4 v[112:115], v28, s[12:15], s56 offen nt
    s_add_u32 s56, s56, 24576
    buffer_load_dwordx4 v[116:119], v28, s[12:15], s56 offen nt
    s_add_u32 s56, s56, 24576
    buffer_load_dwordx4 v[120:123], v28, s[12:15], s56 offen nt
    s_add_u32 s56, s56, 24576
    buffer_load_dwordx4 v[124:127], v28, s[12:15], s56 offen nt
    s_mul_i32 s56, s4, 81920
    s_mul_i32 s57, s3, 320
    s_add_u32 s56, s56, s57
    s_add_u32 s57, s56, 40960
    s_mov_b32 s42, 6554
    v_add_u32 v28, 0, v0
    v_mul_u32_u24 v29, s42, v28
    v_lshrrev_b32 v29, 16, v29
    v_mul_u32_u24 v30, 10, v29
    v_sub_u32 v28, v28, v30
    v_mul_u32_u24 v29, 1280, v29
    v_lshl_add_u32 v208, v28, 4, v29
    v_add_u32 v28, 64, v0
    v_mul_u32_u24 v29, s42, v28
    v_lshrrev_b32 v29, 16, v29
    v_mul_u32_u24 v30, 10, v29
    v_sub_u32 v28, v28, v30
    v_mul_u32_u24 v29, 1280, v29
    v_lshl_add_u32 v209, v28, 4, v29
    v_add_u32 v28, 128, v0
    v_mul_u32_u24 v29, s42, v28
    v_lshrrev_b32 v29, 16, v29
    v_mul_u32_u24 v30, 10, v29
    v_sub_u32 v28, v28, v30
    v_mul_u32_u24 v29, 1280, v29
    v_lshl_add_u32 v210, v28, 4, v29
    v_add_u32 v28, 192, v0
    v_mul_u32_u24 v29, s42, v28
    v_lshrrev_b32 v29, 16, v29
    v_mul_u32_u24 v30, 10, v29
    v_sub_u32 v28, v28, v30
    v_mul_u32_u24 v29, 1280, v29
    v_lshl_add_u32 v211, v28, 4, v29
    v_add_u32 v28, 256, v0
    v_mul_u32_u24 v29, s42, v28
    v_lshrrev_b32 v29, 16, v29
    v_mul_u32_u24 v30, 10, v29
    v_sub_u32 v28, v28, v30
    v_mul_u32_u24 v29, 1280, v29
    v_lshl_add_u32 v212, v28, 4, v29
    buffer_load_dwordx4 v[128:131], v208, s[48:51], s56 offen offset:0 nt
    buffer_load_dwordx4 v[132:135], v209, s[48:51], s56 offen offset:0 nt
    buffer_load_dwordx4 v[136:139], v210, s[48:51], s56 offen offset:0 nt
    buffer_load_dwordx4 v[140:143], v211, s[48:51], s56 offen offset:0 nt
    buffer_load_dwordx4 v[144:147], v212, s[48:51], s56 offen offset:0 nt
    buffer_load_dwordx4 v[148:151], v208, s[48:51], s56 offen offset:160 nt
    buffer_load_dwordx4 v[152:155], v209, s[48:51], s56 offen offset:160 nt
    buffer_load_dwordx4 v[156:159], v210, s[48:51], s56 offen offset:160 nt
    buffer_load_dwordx4 v[160:163], v211, s[48:51], s56 offen offset:160 nt
    buffer_load_dwordx4 v[164:167], v212, s[48:51], s56 offen offset:160 nt
    buffer_load_dwordx4 v[168:171], v208, s[48:51], s57 offen offset:0 nt
    buffer_load_dwordx4 v[172:175], v209, s[48:51], s57 offen offset:0 nt
    buffer_load_dwordx4 v[176:179], v210, s[48:51], s57 offen offset:0 nt
    buffer_load_dwordx4 v[180:183], v211, s[48:51], s57 offen offset:0 nt
    buffer_load_dwordx4 v[184:187], v212, s[48:51], s57 offen offset:0 nt
    buffer_load_dwordx4 v[188:191], v208, s[48:51], s57 offen offset:160 nt
    buffer_load_dwordx4 v[192:195], v209, s[48:51], s57 offen offset:160 nt
    buffer_load_dwordx4 v[196:199], v210, s[48:51], s57 offen offset:160 nt
    buffer_load_dwordx4 v[200:203], v211, s[48:51], s57 offen offset:160 nt
    buffer_load_dwordx4 v[204:207], v212, s[48:51], s57 offen offset:160 nt
    s_waitcnt vmcnt(36) lgkmcnt(4)
    ds_write_b128 v10, v[48:51] offset:0
    ds_write_b128 v10, v[52:55] offset:1024
    ds_write_b128 v10, v[56:59] offset:2048
    ds_write_b128 v10, v[60:63] offset:3072
    s_waitcnt vmcnt(32) lgkmcnt(4)
    ds_write_b128 v10, v[64:67] offset:4096
    ds_write_b128 v10, v[68:71] offset:5120
    ds_write_b128 v10, v[72:75] offset:6144
    ds_write_b128 v10, v[76:79] offset:7168
    s_waitcnt vmcnt(28) lgkmcnt(4)
    ds_write_b128 v10, v[80:83] offset:8192
    ds_write_b128 v10, v[84:87] offset:9216
    ds_write_b128 v10, v[88:91] offset:10240
    ds_write_b128 v10, v[92:95] offset:11264
    s_waitcnt vmcnt(24) lgkmcnt(4)
    ds_write_b128 v10, v[96:99] offset:12288
    ds_write_b128 v10, v[100:103] offset:13312
    ds_write_b128 v10, v[104:107] offset:14336
    ds_write_b128 v10, v[108:111] offset:15360
    s_waitcnt vmcnt(20) lgkmcnt(4)
    ds_write_b128 v10, v[112:115] offset:16384
    ds_write_b128 v10, v[116:119] offset:17408
    ds_write_b128 v10, v[120:123] offset:18432
    ds_write_b128 v10, v[124:127] offset:19456
    v_mov_b32 v5, 1
    s_mov_b64 exec, 1
    s_waitcnt lgkmcnt(0)
    ds_add_u32 v18, v5 offset:8668
    s_mov_b64 exec, -1
    s_mov_b32 s57, 320000
L_w_88:
    ds_read_b32 v5, v18 offset:8668
    s_sub_u32 s57, s57, 1
    s_waitcnt lgkmcnt(0)
    v_readfirstlane_b32 s7, v5
    s_cmp_eq_u32 s57, 0
    s_cbranch_scc1 L_wok_89
    s_cmp_ge_u32 s7, 4
    s_cbranch_scc1 L_wok_89
    s_sleep 4
    s_branch L_w_88
L_wok_89:
    ds_read_b64_tr_b16 v[48:49], v11 offset:0
    ds_read_b64_tr_b16 v[50:51], v11 offset:512
    ds_read_b64_tr_b16 v[52:53], v11 offset:4096
    ds_read_b64_tr_b16 v[54:55], v11 offset:4608
    ds_read_b64_tr_b16 v[56:57], v11 offset:8192
    ds_read_b64_tr_b16 v[58:59], v11 offset:8704
    ds_read_b64_tr_b16 v[60:61], v11 offset:12288
    ds_read_b64_tr_b16 v[62:63], v11 offset:12800
    s_waitcnt lgkmcnt(4)
    ds_read_b64_tr_b16 v[64:65], v11 offset:16384
    ds_read_b64_tr_b16 v[66:67], v11 offset:16896
    ds_read_b64_tr_b16 v[68:69], v11 offset:20480
    ds_read_b64_tr_b16 v[70:71], v11 offset:20992
    ds_read_b64_tr_b16 v[72:73], v11 offset:24576
    ds_read_b64_tr_b16 v[74:75], v11 offset:25088
    ds_read_b64_tr_b16 v[76:77], v11 offset:28672
    ds_read_b64_tr_b16 v[78:79], v11 offset:29184
    s_waitcnt lgkmcnt(4)
    ds_read_b64_tr_b16 v[80:81], v11 offset:32768
    ds_read_b64_tr_b16 v[82:83], v11 offset:33280
    ds_read_b64_tr_b16 v[84:85], v11 offset:36864
    ds_read_b64_tr_b16 v[86:87], v11 offset:37376
    ds_read_b64_tr_b16 v[88:89], v13 offset:0
    ds_read_b64_tr_b16 v[90:91], v13 offset:512
    ds_read_b64_tr_b16 v[92:93], v13 offset:4096
    ds_read_b64_tr_b16 v[94:95], v13 offset:4608
    s_waitcnt lgkmcnt(4)
    ds_read_b64_tr_b16 v[96:97], v13 offset:8192
    ds_read_b64_tr_b16 v[98:99], v13 offset:8704
    ds_read_b64_tr_b16 v[100:101], v13 offset:12288
    ds_read_b64_tr_b16 v[102:103], v13 offset:12800
    ds_read_b64_tr_b16 v[104:105], v13 offset:16384
    ds_read_b64_tr_b16 v[106:107], v13 offset:16896
    ds_read_b64_tr_b16 v[108:109], v13 offset:20480
    ds_read_b64_tr_b16 v[110:111], v13 offset:20992
    s_waitcnt lgkmcnt(4)
    ds_read_b64_tr_b16 v[112:113], v13 offset:24576
    ds_read_b64_tr_b16 v[114:115], v13 offset:25088
    ds_read_b64_tr_b16 v[116:117], v13 offset:28672
    ds_read_b64_tr_b16 v[118:119], v13 offset:29184
    ds_read_b64_tr_b16 v[120:121], v13 offset:32768
    ds_read_b64_tr_b16 v[122:123], v13 offset:33280
    ds_read_b64_tr_b16 v[124:125], v13 offset:36864
    ds_read_b64_tr_b16 v[126:127], v13 offset:37376
    s_mov_b32 s57, 320000
L_w_90:
    ds_read_b32 v5, v18 offset:8652
    s_sub_u32 s57, s57, 1
    s_waitcnt lgkmcnt(0)
    v_readfirstlane_b32 s7, v5
    s_cmp_eq_u32 s57, 0
    s_cbranch_scc1 L_wok_91
    s_cmp_ge_u32 s7, 4
    s_cbranch_scc1 L_wok_91
    s_sleep 4
    s_branch L_w_90
L_wok_91:
    v_add_u32 v6, 144896, v12
    ds_read_b128 v[208:211], v6 offset:0
    s_waitcnt lgkmcnt(0)
    v_mfma_f32_16x16x32_bf16 v[36:39], v[208:211], v[48:51], 0
    s_nop 1
    ds_read_b128 v[208:211], v6 offset:64
    s_waitcnt lgkmcnt(0)
    v_mfma_f32_16x16x32_bf16 v[36:39], v[208:211], v[52:55], v[36:39]
    s_nop 1
    ds_read_b128 v[208:211], v6 offset:128
    s_waitcnt lgkmcnt(0)
    v_mfma_f32_16x16x32_bf16 v[36:39], v[208:211], v[56:59], v[36:39]
    s_nop 1
    ds_read_b128 v[208:211], v6 offset:192
    s_waitcnt lgkmcnt(0)
    v_mfma_f32_16x16x32_bf16 v[36:39], v[208:211], v[60:63], v[36:39]
    s_nop 1
    ds_read_b128 v[208:211], v6 offset:256
    s_waitcnt lgkmcnt(0)
    v_mfma_f32_16x16x32_bf16 v[36:39], v[208:211], v[64:67], v[36:39]
    s_nop 1
    ds_read_b128 v[208:211], v6 offset:320
    s_waitcnt lgkmcnt(0)
    v_mfma_f32_16x16x32_bf16 v[36:39], v[208:211], v[68:71], v[36:39]
    s_nop 1
    ds_read_b128 v[208:211], v6 offset:384
    s_waitcnt lgkmcnt(0)
    v_mfma_f32_16x16x32_bf16 v[36:39], v[208:211], v[72:75], v[36:39]
    s_nop 1
    ds_read_b128 v[208:211], v6 offset:448
    s_waitcnt lgkmcnt(0)
    v_mfma_f32_16x16x32_bf16 v[36:39], v[208:211], v[76:79], v[36:39]
    s_nop 1
    ds_read_b128 v[208:211], v6 offset:512
    s_waitcnt lgkmcnt(0)
    v_mfma_f32_16x16x32_bf16 v[36:39], v[208:211], v[80:83], v[36:39]
    s_nop 1
    ds_read_b128 v[208:211], v6 offset:576
    s_waitcnt lgkmcnt(0)
    v_mfma_f32_16x16x32_bf16 v[36:39], v[208:211], v[84:87], v[36:39]
    s_nop 1
    ds_read_b128 v[208:211], v6 offset:640
    s_waitcnt lgkmcnt(0)
    v_mfma_f32_16x16x32_bf16 v[36:39], v[208:211], v[88:91], v[36:39]
    s_nop 1
    ds_read_b128 v[208:211], v6 offset:704
    s_waitcnt lgkmcnt(0)
    v_mfma_f32_16x16x32_bf16 v[36:39], v[208:211], v[92:95], v[36:39]
    s_nop 1
    ds_read_b128 v[208:211], v6 offset:768
    s_waitcnt lgkmcnt(0)
    v_mfma_f32_16x16x32_bf16 v[36:39], v[208:211], v[96:99], v[36:39]
    s_nop 1
    ds_read_b128 v[208:211], v6 offset:832
    s_waitcnt lgkmcnt(0)
    v_mfma_f32_16x16x32_bf16 v[36:39], v[208:211], v[100:103], v[36:39]
    s_nop 1
    ds_read_b128 v[208:211], v6 offset:896
    s_waitcnt lgkmcnt(0)
    v_mfma_f32_16x16x32_bf16 v[36:39], v[208:211], v[104:107], v[36:39]
    s_nop 1
    ds_read_b128 v[208:211], v6 offset:960
    s_waitcnt lgkmcnt(0)
    v_mfma_f32_16x16x32_bf16 v[36:39], v[208:211], v[108:111], v[36:39]
    s_nop 1
    ds_read_b128 v[208:211], v6 offset:1024
    s_waitcnt lgkmcnt(0)
    v_mfma_f32_16x16x32_bf16 v[36:39], v[208:211], v[112:115], v[36:39]
    s_nop 1
    ds_read_b128 v[208:211], v6 offset:1088
    s_waitcnt lgkmcnt(0)
    v_mfma_f32_16x16x32_bf16 v[36:39], v[208:211], v[116:119], v[36:39]
    s_nop 1
    ds_read_b128 v[208:211], v6 offset:1152
    s_waitcnt lgkmcnt(0)
    v_mfma_f32_16x16x32_bf16 v[36:39], v[208:211], v[120:123], v[36:39]
    s_nop 1
    ds_read_b128 v[208:211], v6 offset:1216
    s_waitcnt lgkmcnt(0)
    v_mfma_f32_16x16x32_bf16 v[36:39], v[208:211], v[124:127], v[36:39]
    s_nop 1
    s_nop 7
    v_mov_b32 v4, v36
    v_mov_b32 v5, v37
    s_waitcnt vmcnt(15) lgkmcnt(0)
    ds_write_b128 v44, v[128:131] offset:0
    ds_write_b128 v44, v[132:135] offset:1024
    ds_write_b128 v44, v[136:139] offset:2048
    ds_write_b128 v44, v[140:143] offset:3072
    ds_write_b128 v44, v[144:147] offset:4096
    s_waitcnt lgkmcnt(0)
    ds_read_b64_tr_b16 v[128:129], v46 offset:0
    ds_read_b64_tr_b16 v[130:131], v46 offset:640
    ds_read_b64_tr_b16 v[132:133], v46 offset:32
    ds_read_b64_tr_b16 v[134:135], v46 offset:672
    ds_read_b64_tr_b16 v[136:137], v46 offset:64
    ds_read_b64_tr_b16 v[138:139], v46 offset:704
    ds_read_b64_tr_b16 v[140:141], v46 offset:96
    ds_read_b64_tr_b16 v[142:143], v46 offset:736
    ds_read_b64_tr_b16 v[144:145], v46 offset:128
    ds_read_b64_tr_b16 v[146:147], v46 offset:768
    s_waitcnt vmcnt(10) lgkmcnt(0)
    ds_write_b128 v44, v[148:151] offset:0
    ds_write_b128 v44, v[152:155] offset:1024
    ds_write_b128 v44, v[156:159] offset:2048
    ds_write_b128 v44, v[160:163] offset:3072
    ds_write_b128 v44, v[164:167] offset:4096
    s_waitcnt lgkmcnt(0)
    ds_read_b64_tr_b16 v[148:149], v46 offset:0
    ds_read_b64_tr_b16 v[150:151], v46 offset:640
    ds_read_b64_tr_b16 v[152:153], v46 offset:32
    ds_read_b64_tr_b16 v[154:155], v46 offset:672
    ds_read_b64_tr_b16 v[156:157], v46 offset:64
    ds_read_b64_tr_b16 v[158:159], v46 offset:704
    ds_read_b64_tr_b16 v[160:161], v46 offset:96
    ds_read_b64_tr_b16 v[162:163], v46 offset:736
    ds_read_b64_tr_b16 v[164:165], v46 offset:128
    ds_read_b64_tr_b16 v[166:167], v46 offset:768
    s_waitcnt vmcnt(5) lgkmcnt(0)
    ds_write_b128 v44, v[168:171] offset:0
    ds_write_b128 v44, v[172:175] offset:1024
    ds_write_b128 v44, v[176:179] offset:2048
    ds_write_b128 v44, v[180:183] offset:3072
    ds_write_b128 v44, v[184:187] offset:4096
    s_waitcnt lgkmcnt(0)
    ds_read_b64_tr_b16 v[168:169], v46 offset:0
    ds_read_b64_tr_b16 v[170:171], v46 offset:640
    ds_read_b64_tr_b16 v[172:173], v46 offset:32
    ds_read_b64_tr_b16 v[174:175], v46 offset:672
    ds_read_b64_tr_b16 v[176:177], v46 offset:64
    ds_read_b64_tr_b16 v[178:179], v46 offset:704
    ds_read_b64_tr_b16 v[180:181], v46 offset:96
    ds_read_b64_tr_b16 v[182:183], v46 offset:736
    ds_read_b64_tr_b16 v[184:185], v46 offset:128
    ds_read_b64_tr_b16 v[186:187], v46 offset:768
    s_waitcnt vmcnt(0) lgkmcnt(0)
    ds_write_b128 v44, v[188:191] offset:0
    ds_write_b128 v44, v[192:195] offset:1024
    ds_write_b128 v44, v[196:199] offset:2048
    ds_write_b128 v44, v[200:203] offset:3072
    ds_write_b128 v44, v[204:207] offset:4096
    s_waitcnt lgkmcnt(0)
    ds_read_b64_tr_b16 v[188:189], v46 offset:0
    ds_read_b64_tr_b16 v[190:191], v46 offset:640
    ds_read_b64_tr_b16 v[192:193], v46 offset:32
    ds_read_b64_tr_b16 v[194:195], v46 offset:672
    ds_read_b64_tr_b16 v[196:197], v46 offset:64
    ds_read_b64_tr_b16 v[198:199], v46 offset:704
    ds_read_b64_tr_b16 v[200:201], v46 offset:96
    ds_read_b64_tr_b16 v[202:203], v46 offset:736
    ds_read_b64_tr_b16 v[204:205], v46 offset:128
    ds_read_b64_tr_b16 v[206:207], v46 offset:768
    s_mov_b32 s57, 320000
L_w_92:
    ds_read_b32 v6, v18 offset:8648
    s_sub_u32 s57, s57, 1
    s_waitcnt lgkmcnt(0)
    v_readfirstlane_b32 s7, v6
    s_cmp_eq_u32 s57, 0
    s_cbranch_scc1 L_wok_93
    s_cmp_ge_u32 s7, 5
    s_cbranch_scc1 L_wok_93
    s_sleep 2
    s_branch L_w_92
L_wok_93:
    s_setprio 3
    s_branch L_t4
L_end:
    s_endpgm
    .p2align 2
L_table:
    .long 0xff206000
    .long 0xffa0ff40
    .long 0x6e21ff01
    .long 0xffa1ff41
    .long 0xff22ff02
    .long 0xffa27c42
    .long 0xff23ff03
    .long 0x8aa3ff43
    .long 0xff246104
    .long 0xffa4ff44
    .long 0x6f25ff05
    .long 0xffa5ff45
    .long 0xff26ff06
    .long 0xffa67d46
    .long 0xff27ff07
    .long 0x8ba7ff47
    .long 0xff286208
    .long 0xffa8ff48
    .long 0x7029ff09
    .long 0xffa9ff49
    .long 0xff2aff0a
    .long 0xffaa7e4a
    .long 0xff2bff0b
    .long 0x8cabff4b
    .long 0xff2c630c
    .long 0xffacff4c
    .long 0x712dff0d
    .long 0xffadff4d
    .long 0xff2eff0e
    .long 0xffae7f4e
    .long 0xff2fff0f
    .long 0x8dafff4f
    .long 0xff306410
    .long 0xffb0ff50
    .long 0x7231ff11
    .long 0xffb1ff51
    .long 0xff32ff12
    .long 0xffb28052
    .long 0xff33ff13
    .long 0x8eb3ff53
    .long 0xff346514
    .long 0xffb4ff54
    .long 0x7335ff15
    .long 0xffb5ff55
    .long 0xff36ff16
    .long 0xffb68156
    .long 0xff37ff17
    .long 0x8fb7ff57
    .long 0x74386618
    .long 0x90988258
    .long 0x75396719
    .long 0x91998359
    .long 0x763a681a
    .long 0x929a845a
    .long 0x773b691b
    .long 0x939b855b
    .long 0x783c6a1c
    .long 0x949c865c
    .long 0x793d6b1d
    .long 0x959d875d
    .long 0x7a3e6c1e
    .long 0x969e885e
    .long 0x7b3f6d1f
    .long 0x979f895f
.section .rodata,"a"
.p2align 6
.amdhsa_kernel adaLN_cond__gqa_block_cached__dense_activation_silu__decode_kernel
  .amdhsa_next_free_vgpr 256
  .amdhsa_next_free_sgpr 102
  .amdhsa_accum_offset 256
  .amdhsa_group_segment_fixed_size 0
  .amdhsa_kernarg_size 104
  .amdhsa_user_sgpr_count 2
  .amdhsa_user_sgpr_kernarg_segment_ptr 1
  .amdhsa_system_sgpr_workgroup_id_x 1
  .amdhsa_float_denorm_mode_32 3
.end_amdhsa_kernel
```
